```python
import torch

def _softmax(x, axis=-1):
    return torch.softmax(x, dim=axis)
def _gelu(x):
    return torch.nn.functional.gelu(x, approximate="tanh")
def _silu(x):
    return torch.nn.functional.silu(x)
def _sigmoid(x):
    return torch.sigmoid(x)
def _layernorm(x, axis=-1, eps=1e-5):
    m = x.mean(dim=axis, keepdim=True)
    v = x.var(dim=axis, keepdim=True, unbiased=False)
    return (x - m) / torch.sqrt(v + eps)
def _scatter_add(tgt, idx, src, axis=0):
    return tgt.clone().index_add_(axis, idx, src)
def _segment_sum(src, seg, n):
    out = torch.zeros((n,) + src.shape[1:], dtype=src.dtype)
    return out.index_add_(0, seg, src)
def _pad(x, pw):
    flat = tuple(v for pair in reversed(pw) for v in pair)
    return torch.nn.functional.pad(x, flat)

kernel_name = 'gather_scatter__cheap_equivariant_egnn__graph'

def setup_inputs():

    _w = (lambda a: (lambda t: t.to(torch.bfloat16) if t.is_floating_point() else t)(torch.as_tensor(a)))
    N, deg, D, De = 25000, 16, 128, max(16, 1)
    E = N * deg
    return {
        "h": _w((lambda *s: torch.randn(*s, dtype=torch.bfloat16) * 0.2)(N, D)),
        "pos": _w((lambda *s: torch.randn(*s, dtype=torch.bfloat16) * 0.4)(N, 3)),
        "e_attr": _w((lambda *s: torch.randn(*s, dtype=torch.bfloat16) * 0.4)(E, De)),
        "src": _w((lambda lo, hi, *s: torch.randint(lo, hi, s))(0, N, E).to(torch.int64)),
        "dst": _w((lambda lo, hi, *s: torch.randint(lo, hi, s))(0, N, E).to(torch.int64)),
        "w_e": _w(0.1 * (lambda *s: torch.randn(*s, dtype=torch.bfloat16) * 0.4)(2 * D + 1 + De, D)),
        "w_x": _w(0.1 * (lambda *s: torch.randn(*s, dtype=torch.bfloat16) * 0.2)(D, 1)),
        "w_h": _w(0.1 * (lambda *s: torch.randn(*s, dtype=torch.bfloat16) * 0.2)(2 * D, D)),
    }

def reference(h, pos, e_attr, src, dst, w_e, w_x, w_h):
    N, D = h.shape[0], h.shape[1]
    diff = pos[dst] - pos[src]
    dist2 = torch.sum(diff * diff, axis=-1, keepdims=True)
    e_in = torch.concatenate([h[dst], h[src], dist2, e_attr], axis=-1)
    m_ij = _silu(e_in @ w_e)
    coord_scale = m_ij @ w_x
    pos_new = pos + _segment_sum(diff * coord_scale, dst, N)
    m_i = _segment_sum(m_ij, dst, N)
    h_new = h + _silu(torch.concatenate([h, m_i], axis=-1) @ w_h)
    return h_new, pos_new
```

```asm
; @launch grid=(256,1,1) block=(256,1,1) lds=163840
.amdgcn_target "amdgcn-amd-amdhsa--gfx950"
.text
.globl gather_scatter__cheap_equivariant_egnn__graph_kernel
.p2align 8
.type gather_scatter__cheap_equivariant_egnn__graph_kernel,@function
gather_scatter__cheap_equivariant_egnn__graph_kernel:
s_cmp_ge_u32 s2, 256
s_cbranch_scc1 K2_END
s_load_dwordx2 s[60:61], s[0:1], 32
s_getpc_b64 s[56:57]
v_min_u32 v40, ((K2_RARE-gather_scatter__cheap_equivariant_egnn__graph_kernel)/128)-1, v0
v_mov_b32 v41, 0
v_lshlrev_b32 v40, 7, v40
v_lshl_add_u64 v[40:41], v[40:41], 0, s[56:57]
global_load_dword v36, v[40:41], off
s_load_dwordx2 s[24:25], s[0:1], 0
s_load_dwordx2 s[68:69], s[0:1], 40
s_load_dwordx2 s[4:5], s[0:1], 56
s_load_dwordx2 s[80:81], s[0:1], 72
s_load_dwordx2 s[64:65], s[0:1], 24
s_load_dwordx2 s[12:13], s[0:1], 8
s_load_dwordx2 s[16:17], s[0:1], 80
s_load_dwordx2 s[8:9], s[0:1], 16
s_load_dwordx2 s[20:21], s[0:1], 48
s_memrealtime s[38:39]
v_lshlrev_b32 v44, 4, v0
s_mul_i32 s56, s2, 6272
v_lshrrev_b32 v1, 6, v0
s_mov_b32 s62, 1600000
v_add_u32 v2, s56, v44
v_readfirstlane_b32 s30, v1
v_add_u32 v3, 4096, v2
v_cmp_gt_u32 vcc, 136, v0
v_cmp_gt_u32 s[78:79], s62, v3
v_cmp_gt_u32 s[76:77], s62, v2
v_bfrev_b32 v43, 2
s_mov_b32 s63, 0x20000
s_and_b64 s[78:79], s[78:79], vcc
s_mov_b32 s66, 1600000
s_mov_b32 s67, 0x20000
v_cndmask_b32 v24, v43, v3, s[78:79]
v_mov_b32 v254, v0
v_and_b32 v4, 63, v0
s_and_b32 s56, s2, 7
s_lshl_b32 s56, s56, 5
s_lshr_b32 s57, s2, 3
s_add_u32 s75, s56, s57
s_mul_i32 s28, s75, 98
v_lshrrev_b32 v32, 4, v4
v_and_b32 v33, 15, v4
v_xor_b32 v208, v32, v33
v_lshlrev_b32 v208, 4, v208
v_lshl_or_b32 v208, v32, 8, v208
s_lshl_b32 s56, s30, 6
v_xor_b32 v30, s56, v208
v_or_b32 v25, s2, v0
v_lshlrev_b32 v25, 8, v25
v_lshlrev_b32 v1, 4, v4
s_mov_b32 s82, 256
s_mov_b32 s83, 0x20000
s_mov_b32 s26, 6400000
s_mov_b32 s27, 0x20000
s_mov_b32 s6, 69888
s_mov_b32 s7, 0x20000
s_lshl_b32 s56, s57, 2
s_add_u32 s56, s56, s30
s_lshl_b32 s45, s28, 8
s_lshl_b32 s3, s30, 10
s_add_u32 s3, s3, s45
s_mul_i32 s59, s30, 1056
s_add_u32 m0, s59, 35744
s_add_u32 s45, s45, 24576
v_mov_b32 v96, 0
v_lshlrev_b32 v42, 2, v0
ds_write_b32 v42, v96 offset:26912
s_sub_u32 s59, s56, 69
s_cselect_b32 s56, s56, s59
s_waitcnt lgkmcnt(0)
buffer_load_dwordx4 v[8:11], v2, s[60:63], 0 offen
s_cselect_b32 s4, s68, s4
s_cselect_b32 s5, s69, s5
buffer_load_dwordx4 v[12:15], v24, s[60:63], 0 offen
buffer_load_dwordx4 v[16:19], v2, s[64:67], 0 offen
buffer_load_dwordx4 v[20:23], v24, s[64:67], 0 offen
s_lshl_b32 s56, s56, 10
s_lshl_b32 s39, s39, 23
s_or_b32 s39, s39, 1
v_mov_b32 v26, s38
v_mov_b32 v27, s39
buffer_store_dwordx2 v[26:27], v25, s[80:83], 0 offen sc0 sc1
buffer_load_dwordx4 v[36:39], v1, s[4:7], s56 offen
buffer_load_dwordx4 v30, s[24:27], s3 offen lds
v_lshrrev_b32 v161, 12, v2
v_bfe_u32 v31, v2, 2, 10
v_lshl_or_b32 v161, v161, 16, v31
v_add_u32 v163, 1, v161
v_add_u32 v165, 2, v161
v_add_u32 v167, 3, v161
v_lshrrev_b32 v169, 12, v3
v_bfe_u32 v31, v3, 2, 10
v_lshl_or_b32 v169, v169, 16, v31
v_add_u32 v171, 1, v169
s_add_u32 m0, m0, 4224
s_add_u32 s3, s3, 4096
buffer_load_dwordx4 v30, s[24:27], s3 offen lds
v_add_u32 v173, 2, v169
v_add_u32 v175, 3, v169
v_lshlrev_b32 v31, 2, v32
v_xor_b32 v31, v33, v31
v_lshlrev_b32 v31, 4, v31
v_lshl_or_b32 v45, v32, 8, v31
s_mov_b32 s70, 69888
s_mov_b32 s71, 0x20000
v_add_u32 v31, s28, v0
v_cmp_gt_u32 vcc, 98, v0
v_mul_u32_u24 v46, 6, v31
s_add_u32 m0, m0, 4224
s_add_u32 s3, s3, 4096
buffer_load_dwordx4 v30, s[24:27], s3 offen lds
v_lshlrev_b32 v31, 4, v31
v_cndmask_b32 v46, v43, v46, vcc
v_cndmask_b32 v212, v43, v31, vcc
v_mov_b32 v216, 0
v_mov_b32 v217, 0
v_mov_b32 v218, 0
v_mov_b32 v219, 0
s_mov_b32 s14, 150000
s_mov_b32 s15, 0x20000
v_and_b32 v5, 31, v4
v_lshrrev_b32 v6, 5, v4
s_add_u32 m0, m0, 4224
s_add_u32 s3, s3, 4096
buffer_load_dwordx4 v30, s[24:27], s3 offen lds
v_lshlrev_b32 v26, 2, v4
v_lshlrev_b32 v27, 1, v5
s_movk_i32 s22, 256
s_mov_b32 s23, 0x20000
v_mov_b32 v224, 0
v_mov_b32 v225, 0
v_mov_b32 v226, 0
v_mov_b32 v227, 0
v_mov_b32 v97, 0
v_mov_b32 v98, 0
s_add_u32 m0, m0, 4224
s_add_u32 s3, s3, 4096
buffer_load_dwordx4 v30, s[24:27], s3 offen lds
v_mov_b32 v99, 0
ds_write_b32 v26, v96 offset:61616
s_lshl_b32 s52, s30, 11
s_add_u32 s52, s52, 2080
v_add_u32 v42, s52, v1
ds_write_b128 v42, v[96:99]
ds_write_b128 v42, v[96:99] offset:1024
v_lshlrev_b32 v28, 3, v4
ds_write_b64 v28, v[96:97] offset:30240
v_lshl_add_u32 v7, s30, 5, v5
v_lshlrev_b32 v238, 4, v6
s_add_u32 m0, m0, 4224
s_add_u32 s3, s3, 4096
buffer_load_dwordx4 v30, s[24:27], s3 offen lds
s_mov_b32 s18, 4139648
s_mov_b32 s19, 0x20000
s_mov_b32 s31, 0
s_movk_i32 s34, 1792
s_mov_b32 s74, 0
s_lshl_b32 s46, s30, 14
s_add_u32 s46, s46, 98304
s_add_u32 s47, s46, 4096
s_add_u32 s48, s46, 8192
s_add_u32 s49, s46, 12288
s_add_u32 s4, s16, 4191232
s_mov_b32 m0, 61088
s_mov_b32 exec_hi, 0
buffer_load_dwordx4 v208, s[24:27], s45 offen lds
s_mov_b32 exec_hi, -1
s_addc_u32 s5, s17, 0
s_mov_b32 s54, 6403072
s_mov_b32 s6, 6403072
s_mov_b32 s55, 12800000
s_mov_b32 s10, 12800000
s_mov_b32 s11, 0x20000
s_mov_b32 s50, 2147483680
s_movk_i32 s51, 256
s_sub_u32 s29, 25000, s28
s_min_u32 s29, s29, 98
s_mul_i32 s53, s30, 448
s_lshl_b32 s3, s30, 13
s_add_u32 m0, s3, 98304
s_add_u32 s3, s3, 32768
buffer_load_dwordx4 v45, s[68:71], s3 offen offset:0 lds
s_load_dwordx2 s[24:25], s[0:1], 56
s_movk_i32 s36, 21400
s_movk_i32 s37, -98
v_mov_b32 v25, 1
v_add_u32 v106, 61872, v44
v_add_u32 v107, 94640, v44
v_min_u32 v107, 96736, v107
ds_write_b128 v106, v[96:99] offset:0
s_mov_b32 s45, 1
v_lshrrev_b32 v100, 3, v5
v_and_b32 v101, 3, v5
v_cmp_eq_u32 vcc, v100, v101
ds_write_b128 v106, v[96:99] offset:4096
v_lshlrev_b32 v100, 2, v5
v_and_b32 v101, 16, v100
v_mov_b32 v102, 0x3F80
v_lshlrev_b32 v102, v101, v102
ds_write_b128 v106, v[96:99] offset:8192
v_cndmask_b32 v102, 0, v102, vcc
ds_write_b32 v100, v102 offset:35360
s_waitcnt vmcnt(13)
v_mul_u32_u24 v176, s36, v8
v_mul_u32_u24 v177, s36, v9
v_mul_u32_u24 v178, s36, v10
v_mul_u32_u24 v179, s36, v11
v_lshrrev_b32 v176, 21, v176
v_lshrrev_b32 v177, 21, v177
v_lshrrev_b32 v178, 21, v178
v_lshrrev_b32 v179, 21, v179
v_mad_i32_i24 v8, v176, s37, v8
v_mad_i32_i24 v9, v177, s37, v9
v_mad_i32_i24 v10, v178, s37, v10
v_mad_i32_i24 v11, v179, s37, v11
v_lshlrev_b32 v176, 2, v176
v_lshlrev_b32 v177, 2, v177
v_lshlrev_b32 v178, 2, v178
v_lshlrev_b32 v179, 2, v179
s_barrier
s_mov_b64 exec, s[76:77]
ds_add_rtn_u32 v184, v176, v25 offset:26912
ds_add_rtn_u32 v185, v177, v25 offset:26912
ds_add_rtn_u32 v186, v178, v25 offset:26912
ds_add_rtn_u32 v187, v179, v25 offset:26912
s_mov_b64 exec, -1
buffer_load_dwordx4 v45, s[68:71], s3 offen offset:1024 lds
v_and_b32 v100, 7, v5
v_lshlrev_b32 v100, 2, v100
ds_write_b128 v106, v[96:99] offset:12288
v_lshrrev_b32 v101, 3, v5
v_add_lshl_u32 v100, v100, v101, 8
v_and_b32 v101, 15, v5
v_xor_b32 v101, v6, v101
ds_write_b128 v106, v[96:99] offset:16384
v_lshl_or_b32 v100, v101, 4, v100
v_add_u32 v192, s46, v100
v_lshlrev_b32 v101, 4, v101
v_lshrrev_b32 v102, 2, v7
ds_write_b128 v106, v[96:99] offset:20480
v_mul_u32_u24 v102, 1056, v102
v_and_b32 v103, 3, v7
v_lshl_add_u32 v102, v103, 8, v102
v_cmp_gt_u32 vcc, 98, v7
ds_write_b128 v106, v[96:99] offset:24576
v_add_u32 v102, 35744, v102
v_mov_b32 v35, 31360
s_waitcnt vmcnt(13)
v_mul_u32_u24 v180, s36, v12
v_mul_u32_u24 v181, s36, v13
v_mul_u32_u24 v182, s36, v14
v_mul_u32_u24 v183, s36, v15
v_lshrrev_b32 v180, 21, v180
v_lshrrev_b32 v181, 21, v181
v_lshrrev_b32 v182, 21, v182
v_lshrrev_b32 v183, 21, v183
v_mad_i32_i24 v12, v180, s37, v12
v_mad_i32_i24 v13, v181, s37, v13
v_mad_i32_i24 v14, v182, s37, v14
v_mad_i32_i24 v15, v183, s37, v15
v_lshlrev_b32 v180, 2, v180
v_lshlrev_b32 v181, 2, v181
v_lshlrev_b32 v182, 2, v182
v_lshlrev_b32 v183, 2, v183
s_mov_b64 exec, s[78:79]
ds_add_rtn_u32 v188, v180, v25 offset:26912
ds_add_rtn_u32 v189, v181, v25 offset:26912
ds_add_rtn_u32 v190, v182, v25 offset:26912
ds_add_rtn_u32 v191, v183, v25 offset:26912
s_mov_b64 exec, -1
buffer_load_dwordx4 v45, s[68:71], s3 offen offset:2048 lds
v_mul_u32_u24 v34, 264, v7
v_cndmask_b32 v102, v35, v102, vcc
ds_write_b128 v106, v[96:99] offset:28672
v_lshl_add_u32 v34, v6, 3, v34
v_add_u32 v34, 35744, v34
s_mul_i32 s58, s30, 8448
v_cndmask_b32 v34, v35, v34, vcc
ds_write_b128 v107, v[96:99]
s_add_u32 s58, s58, 35744
v_add_u32 v35, s58, v1
v_xor_b32 v193, 32, v192
v_xor_b32 v49, 32, v101
v_xor_b32 v194, 64, v192
v_xor_b32 v50, 64, v101
v_xor_b32 v195, 96, v192
v_xor_b32 v51, 96, v101
v_xor_b32 v196, 128, v192
v_xor_b32 v52, 128, v101
v_xor_b32 v197, 160, v192
v_xor_b32 v53, 160, v101
buffer_load_dwordx4 v45, s[68:71], s3 offen offset:3072 lds
v_xor_b32 v198, 192, v192
v_xor_b32 v54, 192, v101
v_xor_b32 v199, 224, v192
v_xor_b32 v55, 224, v101
v_add_u32 v48, v102, v101
v_add_u32 v49, v102, v49
v_add_u32 v50, v102, v50
v_add_u32 v51, v102, v51
v_add_u32 v52, v102, v52
v_add_u32 v53, v102, v53
v_add_u32 v54, v102, v54
v_add_u32 v55, v102, v55
v_bfe_u32 v101, v4, 4, 1
v_lshlrev_b32 v102, 3, v101
v_xor_b32 v100, v33, v102
v_lshlrev_b32 v100, 4, v100
v_xor_b32 v200, 3072, v100
v_xor_b32 v201, 2064, v100
v_xor_b32 v202, 1056, v100
v_xor_b32 v203, 48, v100
s_waitcnt lgkmcnt(0)
s_barrier
ds_read_b128 v[108:111], v1 offset:26912
v_lshrrev_b32 v114, 2, v44
s_add_u32 m0, m0, 4096
s_add_u32 s3, s3, 4096
buffer_load_dwordx4 v45, s[68:71], s3 offen offset:0 lds
v_xor_b32 v204, 3136, v100
v_xor_b32 v205, 2128, v100
v_xor_b32 v206, 1120, v100
v_xor_b32 v207, 112, v100
v_bfe_u32 v102, v4, 2, 2
v_and_b32 v103, 3, v4
v_lshlrev_b32 v103, 3, v103
v_lshl_or_b32 v103, v101, 5, v103
v_lshl_add_u32 v104, v6, 3, v102
v_lshl_add_u32 v104, v104, 8, v103
v_lshl_add_u32 v104, v102, 6, v104
v_add_u32 v56, 98304, v104
v_lshrrev_b32 v104, 1, v4
v_xor_b32 v104, v104, v4
v_and_b32 v104, 1, v104
s_waitcnt vmcnt(14)
v_lshl_or_b32 v160, v8, 19, v16
v_lshl_or_b32 v162, v9, 19, v17
v_lshl_or_b32 v164, v10, 19, v18
v_lshl_or_b32 v166, v11, 19, v19
v_lshl_or_b32 v168, v12, 19, v20
v_lshl_or_b32 v170, v13, 19, v21
v_lshl_or_b32 v172, v14, 19, v22
v_lshl_or_b32 v174, v15, 19, v23
s_waitcnt lgkmcnt(0)
v_add_u32 v112, v108, v109
v_add3_u32 v112, v112, v110, v111
ds_read_b32 v24, v114 offset:26912
v_mov_b32 v113, v112
v_mul_u32_u24 v104, 24, v104
v_xor_b32 v60, v104, v56
v_add_u32_dpp v113, v113, v113 row_shr:1 row_mask:0xf bank_mask:0xf bound_ctrl:0
v_cmp_gt_u32 vcc, 224, v0
s_cmp_eq_u32 s30, 3
s_cselect_b32 s59, 2.0, 0
v_add_u32_dpp v113, v113, v113 row_shr:2 row_mask:0xf bank_mask:0xf bound_ctrl:0
v_cndmask_b32 v208, v43, v208, vcc
s_lshl_b32 s43, s28, 8
v_add_u32_dpp v113, v113, v113 row_shr:4 row_mask:0xf bank_mask:0xf bound_ctrl:0
s_lshl_b32 s58, s30, 13
s_add_u32 s43, s43, s58
v_add_u32_dpp v113, v113, v113 row_shr:8 row_mask:0xf bank_mask:0xf bound_ctrl:0
s_add_u32 s43, s43, 3072
s_add_u32 s44, s43, 4096
v_add_u32_dpp v113, v113, v113 row_bcast:15 row_mask:0xa bank_mask:0xf
s_or_b32 s44, s44, s59
v_xor_b32 v57, 64, v56
v_add_u32_dpp v113, v113, v113 row_bcast:31 row_mask:0xc bank_mask:0xf
v_sub_u32 v116, v113, v112
v_add_u32 v117, v116, v108
v_add_u32 v118, v117, v109
v_add_u32 v119, v118, v110
ds_write_b128 v1, v[116:119] offset:27936
ds_read_b32 v176, v176 offset:27936
ds_read_b32 v177, v177 offset:27936
ds_read_b32 v178, v178 offset:27936
ds_read_b32 v179, v179 offset:27936
ds_read_b32 v180, v180 offset:27936
ds_read_b32 v181, v181 offset:27936
ds_read_b32 v182, v182 offset:27936
ds_read_b32 v183, v183 offset:27936
ds_read_b32 v25, v114 offset:27936
buffer_load_dwordx4 v45, s[68:71], s3 offen offset:1024 lds
v_xor_b32 v61, 64, v60
v_xor_b32 v209, 64, v208
v_or_b32 v209, s59, v209
v_xor_b32 v58, 128, v56
v_xor_b32 v62, 128, v60
v_xor_b32 v210, 128, v208
v_or_b32 v210, s59, v210
v_xor_b32 v59, 192, v56
v_xor_b32 v63, 192, v60
v_xor_b32 v211, 192, v208
v_or_b32 v211, s59, v211
v_lshl_add_u32 v104, v6, 2, v102
v_lshl_add_u32 v104, v104, 6, v103
s_lshl_b32 s58, s30, 11
s_add_u32 s58, s58, 61872
v_add_u32 v230, s58, v104
v_lshl_add_u32 v231, v5, 6, s58
v_mov_b32 v233, v231
v_mov_b32 v232, v231
v_cmp_eq_u32 vcc, 0, v6
s_waitcnt lgkmcnt(5)
v_add_lshl_u32 v176, v176, v184, 3
v_add_lshl_u32 v177, v177, v185, 3
v_add_lshl_u32 v178, v178, v186, 3
v_add_lshl_u32 v179, v179, v187, 3
s_mov_b64 exec, s[76:77]
ds_write_b64 v176, v[160:161] offset:14368
ds_write_b64 v177, v[162:163] offset:14368
ds_write_b64 v178, v[164:165] offset:14368
ds_write_b64 v179, v[166:167] offset:14368
s_mov_b64 exec, -1
s_waitcnt lgkmcnt(5)
v_add_lshl_u32 v180, v180, v188, 3
v_add_lshl_u32 v181, v181, v189, 3
v_add_lshl_u32 v182, v182, v190, 3
v_add_lshl_u32 v183, v183, v191, 3
s_mov_b64 exec, s[78:79]
ds_write_b64 v180, v[168:169] offset:14368
ds_write_b64 v181, v[170:171] offset:14368
ds_write_b64 v182, v[172:173] offset:14368
ds_write_b64 v183, v[174:175] offset:14368
s_mov_b64 exec, -1
buffer_load_dwordx4 v45, s[68:71], s3 offen offset:2048 lds
v_cmp_eq_u32 s[72:73], 0, v102
v_lshlrev_b32 v237, 9, v6
v_cndmask_b32 v235, 0, 2, vcc
v_mul_u32_u24 v104, 264, v102
v_add3_u32 v104, v104, v103, s51
v_add_u32 v104, 35488, v104
v_mov_b32 v105, 61616
v_cndmask_b32 v243, v105, v104, vcc
v_add_u32 v104, 1056, v104
v_add_u32 v103, 35488, v103
v_cndmask_b32 v105, v105, v103, s[72:73]
v_cndmask_b32 v244, v105, v104, vcc
v_lshrrev_b32 v104, 2, v5
v_mul_u32_u24 v104, 256, v104
v_lshl_add_u32 v104, v5, 2, v104
v_add_u32 v246, 70320, v104
v_lshlrev_b32 v104, 2, v5
v_mul_u32_u24 v105, 272, v6
v_add_u32 v105, 70064, v105
v_add_u32 v245, v105, v104
buffer_load_dwordx4 v45, s[68:71], s3 offen offset:3072 lds
buffer_load_short_d16_hi v216, v46, s[12:15], 0 offen offset:0
s_lshl_b32 s58, s30, 2
s_add_u32 s58, s58, 96720
v_mov_b32 v223, s58
buffer_load_short_d16_hi v217, v46, s[12:15], 0 offen offset:2
v_lshlrev_b32 v104, 2, v6
v_sub_u32 v104, v5, v104
v_subrev_u32 v105, 16, v104
buffer_load_short_d16_hi v218, v46, s[12:15], 0 offen offset:4
v_and_b32 v100, -12, v104
v_cmp_eq_u32 vcc, 0, v100
v_and_b32 v100, 3, v104
s_lshl_b32 s56, s30, 10
s_add_u32 m0, s56, 10272
s_add_u32 s56, s56, 65792
buffer_load_dwordx4 v45, s[68:71], s56 offen lds
v_bfe_u32 v101, v104, 3, 1
v_lshl_or_b32 v100, v101, 2, v100
v_lshlrev_b32 v100, 4, v100
s_mov_b32 s56, 65536
buffer_load_dword v252, v26, s[68:71], s56 offen
v_add_u32 v100, 35360, v100
v_mov_b32 v101, 61616
v_cndmask_b32 v32, v101, v100, vcc
buffer_load_short_d16_hi v224, v27, s[20:23], 0 offen offset:0
v_and_b32 v100, -12, v105
v_cmp_eq_u32 vcc, 0, v100
v_and_b32 v100, 3, v105
buffer_load_short_d16_hi v225, v27, s[20:23], 0 offen offset:64
v_bfe_u32 v101, v105, 3, 1
v_lshl_or_b32 v100, v101, 2, v100
v_lshlrev_b32 v100, 4, v100
buffer_load_short_d16_hi v226, v27, s[20:23], 0 offen offset:128
v_add_u32 v100, 35360, v100
v_mov_b32 v101, 61616
v_cndmask_b32 v33, v101, v100, vcc
buffer_load_short_d16_hi v227, v27, s[20:23], 0 offen offset:192
v_lshl_add_u32 v47, v4, 2, s52
s_mov_b32 s72, 3216550459
s_mov_b32 s73, 3216550459
s_waitcnt lgkmcnt(0)
s_barrier
ds_read_b128 v[8:11], v44 offset:14368
ds_read_b128 v[12:15], v44 offset:18464
ds_read_b128 v[16:19], v44 offset:22560
ds_read_b128 v[20:23], v44 offset:26656
s_mul_i32 s32, s2, 12544
s_add_u32 s32, s32, 528384
s_add_u32 s33, s32, 4096
s_add_u32 s35, s32, 8192
s_add_u32 s42, s32, 12288
s_movk_i32 s41, 20000
v_accvgpr_write_b32 a244, 0
v_accvgpr_write_b32 a245, 0
v_accvgpr_write_b32 a246, 0
v_accvgpr_write_b32 a247, 0
v_lshrrev_b32 v100, 1, v235
v_mul_u32_u24 v100, 0x3F80, v100
v_accvgpr_write_b32 a65, 0
v_accvgpr_write_b32 a64, v100
v_lshrrev_b32 v29, 1, v44
s_lshl_b32 s40, s2, 11
v_mov_b32 v3, 0
v_cmp_gt_u32 vcc, 16, v0
s_waitcnt lgkmcnt(12)
v_lshl_or_b32 v24, v25, 12, v24
v_cndmask_b32 v2, v43, v44, vcc
s_waitcnt lgkmcnt(3)
buffer_store_dwordx4 v[8:11], v44, s[16:19], s32 offen sc0 sc1
s_waitcnt lgkmcnt(2)
buffer_store_dwordx4 v[12:15], v44, s[16:19], s33 offen sc0 sc1
s_waitcnt lgkmcnt(1)
buffer_store_dwordx4 v[16:19], v44, s[16:19], s35 offen sc0 sc1
s_waitcnt lgkmcnt(0)
buffer_store_dwordx4 v[20:23], v2, s[16:19], s42 offen sc0 sc1
s_waitcnt vmcnt(13)
s_barrier
s_mov_b32 s26, 65536
ds_read_b128 a[248:251], v32
ds_read_b128 a[252:255], v33
ds_read_b128 a[192:195], v48
ds_read_b64_tr_b16 v[128:129], v56 offset:0
ds_read_b64_tr_b16 v[130:131], v56 offset:1024
ds_read_b64_tr_b16 v[132:133], v57 offset:0
ds_read_b64_tr_b16 v[134:135], v57 offset:1024
ds_read_b128 a[196:199], v49
ds_read_b128 a[200:203], v50
ds_read_b128 a[204:207], v51
ds_read_b128 a[208:211], v52
ds_read_b128 a[212:215], v53
ds_read_b128 a[216:219], v54
ds_read_b128 a[220:223], v55
ds_read_b64_tr_b16 v[136:137], v56 offset:4096
ds_read_b64_tr_b16 v[138:139], v56 offset:5120
ds_read_b64_tr_b16 v[140:141], v57 offset:4096
ds_read_b64_tr_b16 v[142:143], v57 offset:5120
s_waitcnt lgkmcnt(13)
v_mfma_f32_32x32x16_bf16 v[64:79], v[128:131], a[192:195], 0
ds_read_b64_tr_b16 v[144:145], v56 offset:8192
ds_read_b64_tr_b16 v[146:147], v56 offset:9216
s_waitcnt lgkmcnt(13)
v_mfma_f32_32x32x16_bf16 v[80:95], v[132:135], a[192:195], 0
ds_read_b64_tr_b16 v[148:149], v57 offset:8192
ds_read_b64_tr_b16 v[150:151], v57 offset:9216
buffer_load_dwordx2 v[32:33], v3, s[80:83], 0 offen sc1
s_waitcnt lgkmcnt(6)
v_mfma_f32_32x32x16_bf16 v[64:79], v[136:139], a[196:199], v[64:79]
ds_read_b64_tr_b16 v[152:153], v56 offset:12288
ds_read_b64_tr_b16 v[154:155], v56 offset:13312
s_waitcnt lgkmcnt(6)
v_mfma_f32_32x32x16_bf16 v[80:95], v[140:143], a[196:199], v[80:95]
ds_read_b64_tr_b16 v[156:157], v57 offset:12288
ds_read_b64_tr_b16 v[158:159], v57 offset:13312
s_waitcnt lgkmcnt(6)
v_mfma_f32_32x32x16_bf16 v[64:79], v[144:147], a[200:203], v[64:79]
ds_read_b64_tr_b16 v[128:129], v56 offset:16384
ds_read_b64_tr_b16 v[130:131], v56 offset:17408
s_waitcnt lgkmcnt(6)
v_mfma_f32_32x32x16_bf16 v[80:95], v[148:151], a[200:203], v[80:95]
ds_read_b64_tr_b16 v[132:133], v57 offset:16384
ds_read_b64_tr_b16 v[134:135], v57 offset:17408
s_waitcnt lgkmcnt(6)
v_mfma_f32_32x32x16_bf16 v[64:79], v[152:155], a[204:207], v[64:79]
ds_read_b64_tr_b16 v[136:137], v56 offset:20480
ds_read_b64_tr_b16 v[138:139], v56 offset:21504
s_waitcnt lgkmcnt(6)
v_mfma_f32_32x32x16_bf16 v[80:95], v[156:159], a[204:207], v[80:95]
ds_read_b64_tr_b16 v[140:141], v57 offset:20480
ds_read_b64_tr_b16 v[142:143], v57 offset:21504
s_waitcnt lgkmcnt(6)
v_mfma_f32_32x32x16_bf16 v[64:79], v[128:131], a[208:211], v[64:79]
ds_read_b64_tr_b16 v[144:145], v56 offset:24576
ds_read_b64_tr_b16 v[146:147], v56 offset:25600
s_waitcnt lgkmcnt(6)
v_mfma_f32_32x32x16_bf16 v[80:95], v[132:135], a[208:211], v[80:95]
ds_read_b64_tr_b16 v[148:149], v57 offset:24576
ds_read_b64_tr_b16 v[150:151], v57 offset:25600
s_waitcnt lgkmcnt(6)
v_mfma_f32_32x32x16_bf16 v[64:79], v[136:139], a[212:215], v[64:79]
ds_read_b64_tr_b16 v[152:153], v56 offset:28672
ds_read_b64_tr_b16 v[154:155], v56 offset:29696
s_waitcnt lgkmcnt(6)
v_mfma_f32_32x32x16_bf16 v[80:95], v[140:143], a[212:215], v[80:95]
ds_read_b64_tr_b16 v[156:157], v57 offset:28672
ds_read_b64_tr_b16 v[158:159], v57 offset:29696
s_lshl_b32 s3, s30, 13
s_add_u32 m0, s3, 131072
s_add_u32 s3, s3, 0
s_waitcnt lgkmcnt(6)
v_mfma_f32_32x32x16_bf16 v[64:79], v[144:147], a[216:219], v[64:79]
ds_read_b64_tr_b16 v[128:129], v58 offset:0
ds_read_b64_tr_b16 v[130:131], v58 offset:1024
buffer_load_dwordx4 v45, s[68:71], s3 offen offset:0 lds
s_waitcnt lgkmcnt(6)
v_mfma_f32_32x32x16_bf16 v[80:95], v[148:151], a[216:219], v[80:95]
ds_read_b64_tr_b16 v[132:133], v59 offset:0
ds_read_b64_tr_b16 v[134:135], v59 offset:1024
s_waitcnt lgkmcnt(6)
v_mfma_f32_32x32x16_bf16 v[64:79], v[152:155], a[220:223], v[64:79]
ds_read_b64_tr_b16 v[136:137], v58 offset:4096
ds_read_b64_tr_b16 v[138:139], v58 offset:5120
buffer_load_dwordx4 v45, s[68:71], s3 offen offset:1024 lds
s_waitcnt lgkmcnt(6)
v_mfma_f32_32x32x16_bf16 v[80:95], v[156:159], a[220:223], v[80:95]
ds_read_b64_tr_b16 v[140:141], v59 offset:4096
ds_read_b64_tr_b16 v[142:143], v59 offset:5120
s_waitcnt lgkmcnt(6)
v_mfma_f32_32x32x16_bf16 v[96:111], v[128:131], a[192:195], 0
ds_read_b64_tr_b16 v[144:145], v58 offset:8192
ds_read_b64_tr_b16 v[146:147], v58 offset:9216
buffer_load_dwordx4 v45, s[68:71], s3 offen offset:2048 lds
s_waitcnt lgkmcnt(6)
v_mfma_f32_32x32x16_bf16 v[112:127], v[132:135], a[192:195], 0
ds_read_b64_tr_b16 v[148:149], v59 offset:8192
ds_read_b64_tr_b16 v[150:151], v59 offset:9216
s_waitcnt lgkmcnt(6)
v_mfma_f32_32x32x16_bf16 v[96:111], v[136:139], a[196:199], v[96:111]
ds_read_b64_tr_b16 v[152:153], v58 offset:12288
ds_read_b64_tr_b16 v[154:155], v58 offset:13312
buffer_load_dwordx4 v45, s[68:71], s3 offen offset:3072 lds
v_mul_f32 v64, s72, v64
v_mul_f32 v65, s72, v65
v_mul_f32 v66, s72, v66
s_waitcnt lgkmcnt(6)
v_mfma_f32_32x32x16_bf16 v[112:127], v[140:143], a[196:199], v[112:127]
ds_read_b64_tr_b16 v[156:157], v59 offset:12288
ds_read_b64_tr_b16 v[158:159], v59 offset:13312
s_add_u32 m0, m0, 4096
s_add_u32 s3, s3, 4096
v_mul_f32 v67, s72, v67
v_mul_f32 v68, s72, v68
v_mul_f32 v69, s72, v69
s_waitcnt lgkmcnt(6)
v_mfma_f32_32x32x16_bf16 v[96:111], v[144:147], a[200:203], v[96:111]
ds_read_b64_tr_b16 v[128:129], v58 offset:16384
ds_read_b64_tr_b16 v[130:131], v58 offset:17408
buffer_load_dwordx4 v45, s[68:71], s3 offen offset:0 lds
s_waitcnt vmcnt(5)
K2_TG:
v_readfirstlane_b32 s39, v33
v_readfirstlane_b32 s38, v32
s_cmp_eq_u32 s39, 0
s_cbranch_scc1 K2_TGW
K2_TGD:
s_and_b32 s39, s39, -2
v_mov_b32 v25, s38
v_or_b32 v24, s39, v24
s_barrier
buffer_store_dwordx2 v[24:25], v29, s[16:19], s40 offen sc0 sc1
v_mul_f32 v70, s72, v70
v_mul_f32 v71, s72, v71
v_cvt_pk_bf16_f32 v64, v64, v65
s_waitcnt lgkmcnt(6)
v_mfma_f32_32x32x16_bf16 v[112:127], v[148:151], a[200:203], v[112:127]
ds_read_b64_tr_b16 v[132:133], v59 offset:16384
ds_read_b64_tr_b16 v[134:135], v59 offset:17408
v_cvt_pk_bf16_f32 v65, v66, v67
v_cvt_pk_bf16_f32 v66, v68, v69
v_cvt_pk_bf16_f32 v67, v70, v71
s_waitcnt lgkmcnt(6)
v_mfma_f32_32x32x16_bf16 v[96:111], v[152:155], a[204:207], v[96:111]
ds_read_b64_tr_b16 v[136:137], v58 offset:20480
ds_read_b64_tr_b16 v[138:139], v58 offset:21504
ds_write_b128 v48, v[64:67]
buffer_load_dwordx4 v45, s[68:71], s3 offen offset:1024 lds
v_mul_f32 v72, s72, v72
v_mul_f32 v73, s72, v73
s_waitcnt lgkmcnt(7)
v_mfma_f32_32x32x16_bf16 v[112:127], v[156:159], a[204:207], v[112:127]
ds_read_b64_tr_b16 v[140:141], v59 offset:20480
ds_read_b64_tr_b16 v[142:143], v59 offset:21504
v_mul_f32 v74, s72, v74
v_mul_f32 v75, s72, v75
v_mul_f32 v76, s72, v76
s_waitcnt lgkmcnt(7)
v_mfma_f32_32x32x16_bf16 v[96:111], v[128:131], a[208:211], v[96:111]
ds_read_b64_tr_b16 v[144:145], v58 offset:24576
ds_read_b64_tr_b16 v[146:147], v58 offset:25600
buffer_load_dwordx4 v45, s[68:71], s3 offen offset:2048 lds
v_mul_f32 v77, s72, v77
v_mul_f32 v78, s72, v78
v_mul_f32 v79, s72, v79
s_waitcnt lgkmcnt(7)
v_mfma_f32_32x32x16_bf16 v[112:127], v[132:135], a[208:211], v[112:127]
ds_read_b64_tr_b16 v[148:149], v59 offset:24576
ds_read_b64_tr_b16 v[150:151], v59 offset:25600
v_cvt_pk_bf16_f32 v72, v72, v73
v_cvt_pk_bf16_f32 v73, v74, v75
v_cvt_pk_bf16_f32 v74, v76, v77
s_waitcnt lgkmcnt(7)
v_mfma_f32_32x32x16_bf16 v[96:111], v[136:139], a[212:215], v[96:111]
ds_read_b64_tr_b16 v[152:153], v58 offset:28672
ds_read_b64_tr_b16 v[154:155], v58 offset:29696
buffer_load_dwordx4 v45, s[68:71], s3 offen offset:3072 lds
v_cvt_pk_bf16_f32 v75, v78, v79
v_mul_f32 v80, s72, v80
v_mul_f32 v81, s72, v81
s_waitcnt lgkmcnt(6)
v_mfma_f32_32x32x16_bf16 v[112:127], v[140:143], a[212:215], v[112:127]
ds_read_b64_tr_b16 v[156:157], v59 offset:28672
ds_read_b64_tr_b16 v[158:159], v59 offset:29696
ds_write_b128 v49, v[72:75]
v_mul_f32 v82, s72, v82
v_mul_f32 v83, s72, v83
s_waitcnt lgkmcnt(7)
v_mfma_f32_32x32x16_bf16 v[96:111], v[144:147], a[216:219], v[96:111]
v_mul_f32 v84, s72, v84
v_mul_f32 v85, s72, v85
v_mul_f32 v86, s72, v86
v_mul_f32 v87, s72, v87
v_cvt_pk_bf16_f32 v80, v80, v81
s_waitcnt lgkmcnt(5)
v_mfma_f32_32x32x16_bf16 v[112:127], v[148:151], a[216:219], v[112:127]
v_cvt_pk_bf16_f32 v81, v82, v83
v_cvt_pk_bf16_f32 v82, v84, v85
v_cvt_pk_bf16_f32 v83, v86, v87
v_mul_f32 v88, s72, v88
v_mul_f32 v89, s72, v89
s_waitcnt lgkmcnt(3)
v_mfma_f32_32x32x16_bf16 v[96:111], v[152:155], a[220:223], v[96:111]
ds_write_b128 v50, v[80:83]
s_waitcnt lgkmcnt(2)
v_mfma_f32_32x32x16_bf16 v[112:127], v[156:159], a[220:223], v[112:127]
s_mov_b32 s22, 6550000
v_mul_f32 v90, s72, v90
v_mul_f32 v91, s72, v91
v_mul_f32 v92, s72, v92
v_mul_f32 v93, s72, v93
v_mul_f32 v94, s72, v94
v_mul_f32 v95, s72, v95
v_cvt_pk_bf16_f32 v88, v88, v89
v_cvt_pk_bf16_f32 v89, v90, v91
v_cvt_pk_bf16_f32 v90, v92, v93
v_cvt_pk_bf16_f32 v91, v94, v95
ds_write_b128 v51, v[88:91]
v_pk_mul_f32 v[96:97], v[96:97], s[72:73]
v_pk_mul_f32 v[98:99], v[98:99], s[72:73]
v_pk_mul_f32 v[100:101], v[100:101], s[72:73]
v_pk_mul_f32 v[102:103], v[102:103], s[72:73]
v_cvt_pk_bf16_f32 v96, v96, v97
v_cvt_pk_bf16_f32 v97, v98, v99
v_cvt_pk_bf16_f32 v98, v100, v101
v_cvt_pk_bf16_f32 v99, v102, v103
ds_write_b128 v52, v[96:99]
v_pk_mul_f32 v[104:105], v[104:105], s[72:73]
v_pk_mul_f32 v[106:107], v[106:107], s[72:73]
v_pk_mul_f32 v[108:109], v[108:109], s[72:73]
v_pk_mul_f32 v[110:111], v[110:111], s[72:73]
v_cvt_pk_bf16_f32 v104, v104, v105
v_cvt_pk_bf16_f32 v105, v106, v107
v_cvt_pk_bf16_f32 v106, v108, v109
v_cvt_pk_bf16_f32 v107, v110, v111
ds_write_b128 v53, v[104:107]
v_pk_mul_f32 v[112:113], v[112:113], s[72:73]
v_pk_mul_f32 v[114:115], v[114:115], s[72:73]
v_pk_mul_f32 v[116:117], v[116:117], s[72:73]
v_pk_mul_f32 v[118:119], v[118:119], s[72:73]
v_cvt_pk_bf16_f32 v112, v112, v113
v_cvt_pk_bf16_f32 v113, v114, v115
v_cvt_pk_bf16_f32 v114, v116, v117
v_cvt_pk_bf16_f32 v115, v118, v119
ds_write_b128 v54, v[112:115]
v_pk_mul_f32 v[120:121], v[120:121], s[72:73]
v_pk_mul_f32 v[122:123], v[122:123], s[72:73]
v_pk_mul_f32 v[124:125], v[124:125], s[72:73]
v_pk_mul_f32 v[126:127], v[126:127], s[72:73]
v_cvt_pk_bf16_f32 v120, v120, v121
v_cvt_pk_bf16_f32 v121, v122, v123
v_cvt_pk_bf16_f32 v122, v124, v125
v_cvt_pk_bf16_f32 v123, v126, v127
ds_write_b128 v55, v[120:123]
ds_read_b128 v[160:163], v35 offset:0
ds_read_b128 v[164:167], v35 offset:1056
ds_read_b128 v[168:171], v35 offset:2112
ds_read_b128 v[172:175], v35 offset:3168
ds_read_b128 v[176:179], v35 offset:4224
ds_read_b128 v[180:183], v35 offset:5280
ds_read_b128 v[184:187], v35 offset:6336
ds_read_b128 v[188:191], v35 offset:7392
s_waitcnt vmcnt(0)
s_barrier
ds_read_b64_tr_b16 v[128:129], v56 offset:32768
ds_read_b64_tr_b16 v[130:131], v56 offset:33792
ds_read_b64_tr_b16 v[132:133], v57 offset:32768
ds_read_b64_tr_b16 v[134:135], v57 offset:33792
ds_read_b64_tr_b16 v[136:137], v56 offset:36864
ds_read_b64_tr_b16 v[138:139], v56 offset:37888
ds_read_b64_tr_b16 v[140:141], v57 offset:36864
ds_read_b64_tr_b16 v[142:143], v57 offset:37888
s_waitcnt lgkmcnt(6)
v_mfma_f32_32x32x16_bf16 v[64:79], v[128:131], a[192:195], 0
ds_read_b64_tr_b16 v[144:145], v56 offset:40960
ds_read_b64_tr_b16 v[146:147], v56 offset:41984
ds_write_b128 v44, v[216:219] offset:0
buffer_store_dwordx4 v[160:163], v208, s[4:7], s43 offen offset:0 sc0 sc1
s_waitcnt lgkmcnt(7)
v_mfma_f32_32x32x16_bf16 v[80:95], v[132:135], a[192:195], 0
ds_read_b64_tr_b16 v[148:149], v57 offset:40960
ds_read_b64_tr_b16 v[150:151], v57 offset:41984
v_subrev_u32 v12, 88032, v56
s_waitcnt lgkmcnt(7)
v_mfma_f32_32x32x16_bf16 v[64:79], v[136:139], a[196:199], v[64:79]
ds_read_b64_tr_b16 v[152:153], v56 offset:45056
ds_read_b64_tr_b16 v[154:155], v56 offset:46080
v_subrev_u32 v13, 88032, v57
s_waitcnt lgkmcnt(7)
v_mfma_f32_32x32x16_bf16 v[80:95], v[140:143], a[196:199], v[80:95]
ds_read_b64_tr_b16 v[156:157], v57 offset:45056
ds_read_b64_tr_b16 v[158:159], v57 offset:46080
v_subrev_u32 v14, 88032, v58
s_waitcnt lgkmcnt(7)
v_mfma_f32_32x32x16_bf16 v[64:79], v[144:147], a[200:203], v[64:79]
ds_read_b64_tr_b16 v[128:129], v56 offset:49152
ds_read_b64_tr_b16 v[130:131], v56 offset:50176
buffer_store_dwordx4 v[164:167], v209, s[4:7], s43 offen offset:1024 sc0 sc1
v_subrev_u32 v15, 88032, v59
s_waitcnt lgkmcnt(6)
v_mfma_f32_32x32x16_bf16 v[80:95], v[148:151], a[200:203], v[80:95]
ds_read_b64_tr_b16 v[132:133], v57 offset:49152
ds_read_b64_tr_b16 v[134:135], v57 offset:50176
s_mov_b32 s57, 6422528
v_lshlrev_b32 v37, 11, v254
v_lshlrev_b32 v38, 2, v254
s_waitcnt lgkmcnt(6)
v_mfma_f32_32x32x16_bf16 v[64:79], v[152:155], a[204:207], v[64:79]
ds_read_b64_tr_b16 v[136:137], v56 offset:53248
ds_read_b64_tr_b16 v[138:139], v56 offset:54272
v_mul_lo_u32 v36, v254, s57
v_mov_b32 v24, s39
v_mov_b32 v31, v45
s_waitcnt lgkmcnt(6)
v_mfma_f32_32x32x16_bf16 v[80:95], v[156:159], a[204:207], v[80:95]
ds_read_b64_tr_b16 v[140:141], v57 offset:53248
ds_read_b64_tr_b16 v[142:143], v57 offset:54272
v_add_u32 v38, 96768, v38
s_waitcnt lgkmcnt(6)
v_mfma_f32_32x32x16_bf16 v[64:79], v[128:131], a[208:211], v[64:79]
ds_read_b64_tr_b16 v[144:145], v56 offset:57344
ds_read_b64_tr_b16 v[146:147], v56 offset:58368
buffer_store_dwordx4 v[168:171], v210, s[4:7], s43 offen offset:2048 sc0 sc1
s_movk_i32 s41, 20000
s_lshl_b32 s40, s2, 3
s_add_u32 s40, s40, 524288
v_cmp_eq_u32 vcc, 0, v254
s_waitcnt lgkmcnt(6)
v_mfma_f32_32x32x16_bf16 v[80:95], v[132:135], a[208:211], v[80:95]
ds_read_b64_tr_b16 v[148:149], v57 offset:57344
ds_read_b64_tr_b16 v[150:151], v57 offset:58368
v_cndmask_b32 v29, v43, 0, vcc
s_waitcnt lgkmcnt(6)
v_mfma_f32_32x32x16_bf16 v[64:79], v[136:139], a[212:215], v[64:79]
ds_read_b64_tr_b16 v[152:153], v56 offset:61440
ds_read_b64_tr_b16 v[154:155], v56 offset:62464
ds_read_b64_tr_b16 a[128:129], v12
s_waitcnt lgkmcnt(7)
v_mfma_f32_32x32x16_bf16 v[80:95], v[140:143], a[212:215], v[80:95]
ds_read_b64_tr_b16 v[156:157], v57 offset:61440
ds_read_b64_tr_b16 v[158:159], v57 offset:62464
ds_read_b64_tr_b16 a[130:131], v12 offset:1024
s_waitcnt lgkmcnt(8)
v_mfma_f32_32x32x16_bf16 v[64:79], v[144:147], a[216:219], v[64:79]
ds_read_b64_tr_b16 v[128:129], v58 offset:32768
ds_read_b64_tr_b16 v[130:131], v58 offset:33792
buffer_store_dwordx4 v[172:175], v211, s[4:7], s43 offen offset:3072 sc0 sc1
ds_read_b64_tr_b16 a[132:133], v13
s_waitcnt lgkmcnt(9)
v_mfma_f32_32x32x16_bf16 v[80:95], v[148:151], a[216:219], v[80:95]
ds_read_b64_tr_b16 v[132:133], v59 offset:32768
ds_read_b64_tr_b16 v[134:135], v59 offset:33792
ds_read_b64_tr_b16 a[134:135], v13 offset:1024
s_waitcnt lgkmcnt(10)
v_mfma_f32_32x32x16_bf16 v[64:79], v[152:155], a[220:223], v[64:79]
ds_read_b64_tr_b16 v[136:137], v58 offset:36864
ds_read_b64_tr_b16 v[138:139], v58 offset:37888
ds_read_b64_tr_b16 a[136:137], v14
s_waitcnt lgkmcnt(10)
v_mfma_f32_32x32x16_bf16 v[80:95], v[156:159], a[220:223], v[80:95]
ds_read_b64_tr_b16 v[140:141], v59 offset:36864
ds_read_b64_tr_b16 v[142:143], v59 offset:37888
ds_read_b64_tr_b16 a[138:139], v14 offset:1024
s_waitcnt lgkmcnt(10)
v_mfma_f32_32x32x16_bf16 v[96:111], v[128:131], a[192:195], 0
ds_read_b64_tr_b16 v[144:145], v58 offset:40960
ds_read_b64_tr_b16 v[146:147], v58 offset:41984
buffer_store_dwordx4 v[176:179], v208, s[4:7], s44 offen offset:0 sc0 sc1
ds_read_b64_tr_b16 a[140:141], v15
s_waitcnt lgkmcnt(10)
v_mfma_f32_32x32x16_bf16 v[112:127], v[132:135], a[192:195], 0
ds_read_b64_tr_b16 v[148:149], v59 offset:40960
ds_read_b64_tr_b16 v[150:151], v59 offset:41984
ds_read_b64_tr_b16 a[142:143], v15 offset:1024
s_waitcnt lgkmcnt(10)
v_mfma_f32_32x32x16_bf16 v[96:111], v[136:139], a[196:199], v[96:111]
ds_read_b64_tr_b16 v[152:153], v58 offset:45056
ds_read_b64_tr_b16 v[154:155], v58 offset:46080
v_mul_f32 v64, s72, v64
v_mul_f32 v65, s72, v65
v_mul_f32 v66, s72, v66
s_waitcnt lgkmcnt(9)
v_mfma_f32_32x32x16_bf16 v[112:127], v[140:143], a[196:199], v[112:127]
ds_read_b64_tr_b16 v[156:157], v59 offset:45056
ds_read_b64_tr_b16 v[158:159], v59 offset:46080
v_mul_f32 v67, s72, v67
v_cvt_pk_bf16_f32 v64, v64, v65
v_cvt_pk_bf16_f32 v65, v66, v67
s_waitcnt lgkmcnt(8)
v_mfma_f32_32x32x16_bf16 v[96:111], v[144:147], a[200:203], v[96:111]
ds_read_b64_tr_b16 v[128:129], v58 offset:49152
ds_read_b64_tr_b16 v[130:131], v58 offset:50176
ds_write_b64 v34, v[64:65] offset:0
buffer_store_dwordx4 v[180:183], v209, s[4:7], s44 offen offset:1024 sc0 sc1
v_mul_f32 v68, s72, v68
v_mul_f32 v69, s72, v69
s_waitcnt lgkmcnt(8)
v_mfma_f32_32x32x16_bf16 v[112:127], v[148:151], a[200:203], v[112:127]
ds_read_b64_tr_b16 v[132:133], v59 offset:49152
ds_read_b64_tr_b16 v[134:135], v59 offset:50176
v_mul_f32 v70, s72, v70
v_mul_f32 v71, s72, v71
v_cvt_pk_bf16_f32 v68, v68, v69
s_waitcnt lgkmcnt(7)
v_mfma_f32_32x32x16_bf16 v[96:111], v[152:155], a[204:207], v[96:111]
ds_read_b64_tr_b16 v[136:137], v58 offset:53248
ds_read_b64_tr_b16 v[138:139], v58 offset:54272
v_cvt_pk_bf16_f32 v69, v70, v71
v_mul_f32 v72, s72, v72
v_mul_f32 v73, s72, v73
s_waitcnt lgkmcnt(7)
v_mfma_f32_32x32x16_bf16 v[112:127], v[156:159], a[204:207], v[112:127]
ds_read_b64_tr_b16 v[140:141], v59 offset:53248
ds_read_b64_tr_b16 v[142:143], v59 offset:54272
ds_write_b64 v34, v[68:69] offset:16
v_mul_f32 v74, s72, v74
v_mul_f32 v75, s72, v75
s_waitcnt lgkmcnt(8)
v_mfma_f32_32x32x16_bf16 v[96:111], v[128:131], a[208:211], v[96:111]
ds_read_b64_tr_b16 v[144:145], v58 offset:57344
ds_read_b64_tr_b16 v[146:147], v58 offset:58368
buffer_store_dwordx4 v[184:187], v210, s[4:7], s44 offen offset:2048 sc0 sc1
v_cvt_pk_bf16_f32 v72, v72, v73
v_cvt_pk_bf16_f32 v73, v74, v75
v_mul_f32 v76, s72, v76
s_waitcnt lgkmcnt(7)
v_mfma_f32_32x32x16_bf16 v[112:127], v[132:135], a[208:211], v[112:127]
ds_read_b64_tr_b16 v[148:149], v59 offset:57344
ds_read_b64_tr_b16 v[150:151], v59 offset:58368
ds_write_b64 v34, v[72:73] offset:32
v_mul_f32 v77, s72, v77
v_mul_f32 v78, s72, v78
s_waitcnt lgkmcnt(8)
v_mfma_f32_32x32x16_bf16 v[96:111], v[136:139], a[212:215], v[96:111]
ds_read_b64_tr_b16 v[152:153], v58 offset:61440
ds_read_b64_tr_b16 v[154:155], v58 offset:62464
v_mul_f32 v79, s72, v79
v_cvt_pk_bf16_f32 v76, v76, v77
v_cvt_pk_bf16_f32 v77, v78, v79
s_waitcnt lgkmcnt(8)
v_mfma_f32_32x32x16_bf16 v[112:127], v[140:143], a[212:215], v[112:127]
ds_read_b64_tr_b16 v[156:157], v59 offset:61440
ds_read_b64_tr_b16 v[158:159], v59 offset:62464
ds_write_b64 v34, v[76:77] offset:48
v_mul_f32 v80, s72, v80
v_mul_f32 v81, s72, v81
s_waitcnt lgkmcnt(8)
v_mfma_f32_32x32x16_bf16 v[96:111], v[144:147], a[216:219], v[96:111]
buffer_store_dwordx4 v[188:191], v211, s[4:7], s44 offen offset:3072 sc0 sc1
v_mul_f32 v82, s72, v82
v_mul_f32 v83, s72, v83
v_cvt_pk_bf16_f32 v80, v80, v81
v_cvt_pk_bf16_f32 v81, v82, v83
v_mul_f32 v84, s72, v84
s_waitcnt lgkmcnt(6)
v_mfma_f32_32x32x16_bf16 v[112:127], v[148:151], a[216:219], v[112:127]
ds_write_b64 v34, v[80:81] offset:64
s_lshl_b32 s56, s75, 3
v_mul_f32 v85, s72, v85
v_mul_f32 v86, s72, v86
v_mul_f32 v87, s72, v87
v_cvt_pk_bf16_f32 v84, v84, v85
s_waitcnt lgkmcnt(4)
v_mfma_f32_32x32x16_bf16 v[96:111], v[152:155], a[220:223], v[96:111]
buffer_load_dwordx2 v[8:9], v37, s[16:19], s56 offen sc1
v_cvt_pk_bf16_f32 v85, v86, v87
v_mul_f32 v88, s72, v88
v_mul_f32 v89, s72, v89
v_mul_f32 v90, s72, v90
s_waitcnt lgkmcnt(2)
v_mfma_f32_32x32x16_bf16 v[112:127], v[156:159], a[220:223], v[112:127]
ds_write_b64 v34, v[84:85] offset:80
v_mul_f32 v91, s72, v91
v_cvt_pk_bf16_f32 v88, v88, v89
v_cvt_pk_bf16_f32 v89, v90, v91
v_mul_f32 v92, s72, v92
v_mul_f32 v93, s72, v93
v_mul_f32 v94, s72, v94
v_mul_f32 v95, s72, v95
v_cvt_pk_bf16_f32 v92, v92, v93
v_cvt_pk_bf16_f32 v93, v94, v95
ds_write_b64 v34, v[88:89] offset:96
ds_write_b64 v34, v[92:93] offset:112
v_pk_mul_f32 v[96:97], v[96:97], s[72:73]
v_pk_mul_f32 v[98:99], v[98:99], s[72:73]
v_cvt_pk_bf16_f32 v96, v96, v97
v_cvt_pk_bf16_f32 v97, v98, v99
v_pk_mul_f32 v[100:101], v[100:101], s[72:73]
v_pk_mul_f32 v[102:103], v[102:103], s[72:73]
v_cvt_pk_bf16_f32 v100, v100, v101
v_cvt_pk_bf16_f32 v101, v102, v103
ds_write_b64 v34, v[96:97] offset:128
ds_write_b64 v34, v[100:101] offset:144
v_pk_mul_f32 v[104:105], v[104:105], s[72:73]
v_pk_mul_f32 v[106:107], v[106:107], s[72:73]
v_cvt_pk_bf16_f32 v104, v104, v105
v_cvt_pk_bf16_f32 v105, v106, v107
v_pk_mul_f32 v[108:109], v[108:109], s[72:73]
v_pk_mul_f32 v[110:111], v[110:111], s[72:73]
v_cvt_pk_bf16_f32 v108, v108, v109
v_cvt_pk_bf16_f32 v109, v110, v111
ds_write_b64 v34, v[104:105] offset:160
ds_write_b64 v34, v[108:109] offset:176
v_pk_mul_f32 v[112:113], v[112:113], s[72:73]
v_pk_mul_f32 v[114:115], v[114:115], s[72:73]
v_cvt_pk_bf16_f32 v112, v112, v113
v_cvt_pk_bf16_f32 v113, v114, v115
v_pk_mul_f32 v[116:117], v[116:117], s[72:73]
v_pk_mul_f32 v[118:119], v[118:119], s[72:73]
v_cvt_pk_bf16_f32 v116, v116, v117
v_cvt_pk_bf16_f32 v117, v118, v119
ds_write_b64 v34, v[112:113] offset:192
ds_write_b64 v34, v[116:117] offset:208
v_pk_mul_f32 v[120:121], v[120:121], s[72:73]
v_pk_mul_f32 v[122:123], v[122:123], s[72:73]
v_cvt_pk_bf16_f32 v120, v120, v121
v_cvt_pk_bf16_f32 v121, v122, v123
v_pk_mul_f32 v[124:125], v[124:125], s[72:73]
v_pk_mul_f32 v[126:127], v[126:127], s[72:73]
v_cvt_pk_bf16_f32 v124, v124, v125
v_cvt_pk_bf16_f32 v125, v126, v127
ds_write_b64 v34, v[120:121] offset:224
ds_write_b64 v34, v[124:125] offset:240
v_lshlrev_b32 v12, 16, v252
v_and_b32 v13, 0xffff0000, v252
v_pk_mul_f32 v[12:13], v[12:13], s[72:73]
v_add_u32 v22, 96768, v1
v_cvt_pk_bf16_f32 v12, v12, v13
ds_write_b32 v26, v12 offset:35488
s_load_dwordx2 s[20:21], s[0:1], 64
s_waitcnt vmcnt(0)
K2_PC:
v_xor_b32 v8, s39, v8
v_xor_b32 v9, s38, v9
v_lshrrev_b32 v20, 23, v8
v_or_b32 v20, v20, v9
v_cmp_ne_u32 vcc, 0, v20
s_and_b64 exec, exec, vcc
s_cbranch_scc1 K2_PW
s_mov_b64 exec, -1
v_add_u32 v8, v36, v8
K2_PD:
ds_write_b32 v38, v8
K2_S3:
s_waitcnt vmcnt(0) lgkmcnt(0)
s_barrier
buffer_store_dwordx2 v[24:25], v29, s[16:19], s40 offen sc0 sc1
K2_R1:
s_lshl_b32 s3, s30, 13
s_add_u32 m0, s3, 98304
s_add_u32 s3, s3, 0
buffer_load_dwordx4 v31, s[24:27], s3 offen offset:0 lds
ds_read_b128 v[24:27], v22
s_waitcnt lgkmcnt(0)
v_and_b32 v16, 0xfff, v24
v_and_b32 v17, 0xfff, v25
v_and_b32 v18, 0xfff, v26
v_and_b32 v19, 0xfff, v27
v_add_u32 v17, v16, v17
v_add_u32 v36, v18, v19
buffer_load_dwordx4 v31, s[24:27], s3 offen offset:1024 lds
v_add_u32 v36, v17, v36
v_add_u32 v18, v17, v18
v_mov_b32 v19, v36
v_add_u32_dpp v36, v36, v36 row_shr:1 row_mask:0xf bank_mask:0xf bound_ctrl:0
v_lshrrev_b32 v24, 12, v24
v_lshrrev_b32 v25, 12, v25
v_add_u32_dpp v36, v36, v36 row_shr:2 row_mask:0xf bank_mask:0xf bound_ctrl:0
v_lshrrev_b32 v26, 12, v26
v_lshrrev_b32 v27, 12, v27
buffer_load_dwordx4 v31, s[24:27], s3 offen offset:2048 lds
v_add_u32_dpp v36, v36, v36 row_shr:4 row_mask:0xf bank_mask:0xf bound_ctrl:0
s_add_u32 s57, s53, s31
s_movk_i32 s56, 448
v_add_u32_dpp v36, v36, v36 row_shr:8 row_mask:0xf bank_mask:0xf bound_ctrl:0
s_lshr_b32 s76, s2, 3
s_lshl2_add_u32 s76, s76, s30
v_add_u32_dpp v36, v36, v36 row_bcast:15 row_mask:0xa bank_mask:0xf
s_mul_i32 s76, s76, 10
v_min_u32 v48, 9, v4
buffer_load_dwordx4 v31, s[24:27], s3 offen offset:3072 lds
v_add_u32_dpp v36, v36, v36 row_bcast:31 row_mask:0xc bank_mask:0xf
v_subrev_u32 v40, s57, v36
v_readlane_b32 s32, v36, 63
v_sub_u32 v36, v40, v19
v_add_u32 v37, v36, v16
v_add_u32 v38, v36, v17
v_add_u32 v39, v36, v18
v_sub_u32 v24, v24, v36
v_sub_u32 v25, v25, v37
s_add_u32 m0, m0, 4096
s_add_u32 s3, s3, 4096
buffer_load_dwordx4 v31, s[24:27], s3 offen offset:0 lds
v_sub_u32 v26, v26, v38
v_sub_u32 v27, v27, v39
v_med3_i32 v36, v36, 0, s56
v_med3_i32 v37, v37, 0, s56
v_med3_i32 v38, v38, 0, s56
v_med3_i32 v39, v39, 0, s56
v_med3_i32 v40, v40, 0, s56
v_add_lshl_u32 v48, v48, s76, 7
v_cmp_lt_i32 s[76:77], v36, v37
buffer_load_dwordx4 v31, s[24:27], s3 offen offset:1024 lds
v_cmp_lt_i32 s[78:79], v37, v38
v_cmp_lt_i32 s[80:81], v38, v39
v_cmp_lt_i32 s[82:83], v39, v40
buffer_load_dword v49, v48, s[12:15], 0 offen
v_lshl_add_u32 v41, v36, 2, s52
v_lshl_add_u32 v42, v37, 2, s52
v_lshl_add_u32 v43, v38, 2, s52
v_lshl_add_u32 v44, v39, 2, s52
s_mov_b64 exec, s[76:77]
ds_write_b32 v41, v24
s_mov_b64 exec, s[78:79]
ds_write_b32 v42, v25
s_mov_b64 exec, s[80:81]
ds_write_b32 v43, v26
s_mov_b64 exec, s[82:83]
ds_write_b32 v44, v27
s_mov_b64 exec, -1
buffer_load_dwordx4 v31, s[24:27], s3 offen offset:2048 lds
ds_read_b32 v40, v47 offset:0
ds_read_b32 v41, v47 offset:256
ds_read_b32 v42, v47 offset:512
ds_read_b32 v43, v47 offset:768
ds_read_b32 v44, v47 offset:1024
ds_read_b32 v45, v47 offset:1280
ds_read_b32 v46, v47 offset:1536
s_sub_u32 s33, s32, s31
s_min_u32 s33, s33, s34
buffer_load_dwordx4 v31, s[24:27], s3 offen offset:3072 lds
s_sub_i32 s76, s33, s53
s_sub_i32 s77, s76, 64
s_sub_i32 s78, s76, 128
s_sub_i32 s79, s76, 192
s_sub_i32 s80, s76, 256
s_sub_i32 s81, s76, 320
s_sub_i32 s82, s76, 384
s_mov_b32 s56, 528384
v_cmp_gt_i32 s[60:61], s76, v4
v_cmp_gt_i32 s[62:63], s77, v4
v_cmp_gt_i32 s[64:65], s78, v4
v_cmp_gt_i32 s[66:67], s79, v4
v_cmp_gt_i32 s[68:69], s80, v4
v_cmp_gt_i32 s[70:71], s81, v4
v_cmp_gt_i32 s[72:73], s82, v4
s_waitcnt lgkmcnt(0)
v_max_u32_dpp v40, v40, v40 row_shr:1 row_mask:0xf bank_mask:0xf bound_ctrl:0
v_max_u32_dpp v41, v41, v41 row_shr:1 row_mask:0xf bank_mask:0xf bound_ctrl:0
v_max_u32_dpp v42, v42, v42 row_shr:1 row_mask:0xf bank_mask:0xf bound_ctrl:0
v_max_u32_dpp v43, v43, v43 row_shr:1 row_mask:0xf bank_mask:0xf bound_ctrl:0
v_max_u32_dpp v44, v44, v44 row_shr:1 row_mask:0xf bank_mask:0xf bound_ctrl:0
v_max_u32_dpp v45, v45, v45 row_shr:1 row_mask:0xf bank_mask:0xf bound_ctrl:0
v_max_u32_dpp v46, v46, v46 row_shr:1 row_mask:0xf bank_mask:0xf bound_ctrl:0
v_max_u32_dpp v40, v40, v40 row_shr:2 row_mask:0xf bank_mask:0xf bound_ctrl:0
v_max_u32_dpp v41, v41, v41 row_shr:2 row_mask:0xf bank_mask:0xf bound_ctrl:0
v_max_u32_dpp v42, v42, v42 row_shr:2 row_mask:0xf bank_mask:0xf bound_ctrl:0
v_max_u32_dpp v43, v43, v43 row_shr:2 row_mask:0xf bank_mask:0xf bound_ctrl:0
v_max_u32_dpp v44, v44, v44 row_shr:2 row_mask:0xf bank_mask:0xf bound_ctrl:0
v_max_u32_dpp v45, v45, v45 row_shr:2 row_mask:0xf bank_mask:0xf bound_ctrl:0
v_max_u32_dpp v46, v46, v46 row_shr:2 row_mask:0xf bank_mask:0xf bound_ctrl:0
v_max_u32_dpp v40, v40, v40 row_shr:4 row_mask:0xf bank_mask:0xf bound_ctrl:0
v_max_u32_dpp v41, v41, v41 row_shr:4 row_mask:0xf bank_mask:0xf bound_ctrl:0
v_max_u32_dpp v42, v42, v42 row_shr:4 row_mask:0xf bank_mask:0xf bound_ctrl:0
v_max_u32_dpp v43, v43, v43 row_shr:4 row_mask:0xf bank_mask:0xf bound_ctrl:0
v_max_u32_dpp v44, v44, v44 row_shr:4 row_mask:0xf bank_mask:0xf bound_ctrl:0
v_max_u32_dpp v45, v45, v45 row_shr:4 row_mask:0xf bank_mask:0xf bound_ctrl:0
v_max_u32_dpp v46, v46, v46 row_shr:4 row_mask:0xf bank_mask:0xf bound_ctrl:0
v_max_u32_dpp v40, v40, v40 row_shr:8 row_mask:0xf bank_mask:0xf bound_ctrl:0
v_max_u32_dpp v41, v41, v41 row_shr:8 row_mask:0xf bank_mask:0xf bound_ctrl:0
v_max_u32_dpp v42, v42, v42 row_shr:8 row_mask:0xf bank_mask:0xf bound_ctrl:0
v_max_u32_dpp v43, v43, v43 row_shr:8 row_mask:0xf bank_mask:0xf bound_ctrl:0
v_max_u32_dpp v44, v44, v44 row_shr:8 row_mask:0xf bank_mask:0xf bound_ctrl:0
v_max_u32_dpp v45, v45, v45 row_shr:8 row_mask:0xf bank_mask:0xf bound_ctrl:0
v_max_u32_dpp v46, v46, v46 row_shr:8 row_mask:0xf bank_mask:0xf bound_ctrl:0
v_max_u32_dpp v40, v40, v40 row_bcast:15 row_mask:0xa bank_mask:0xf
v_max_u32_dpp v41, v41, v41 row_bcast:15 row_mask:0xa bank_mask:0xf
v_max_u32_dpp v42, v42, v42 row_bcast:15 row_mask:0xa bank_mask:0xf
v_max_u32_dpp v43, v43, v43 row_bcast:15 row_mask:0xa bank_mask:0xf
v_max_u32_dpp v44, v44, v44 row_bcast:15 row_mask:0xa bank_mask:0xf
v_max_u32_dpp v45, v45, v45 row_bcast:15 row_mask:0xa bank_mask:0xf
v_max_u32_dpp v46, v46, v46 row_bcast:15 row_mask:0xa bank_mask:0xf
v_max_u32_dpp v40, v40, v40 row_bcast:31 row_mask:0xc bank_mask:0xf
v_max_u32_dpp v41, v41, v41 row_bcast:31 row_mask:0xc bank_mask:0xf
v_max_u32_dpp v42, v42, v42 row_bcast:31 row_mask:0xc bank_mask:0xf
v_max_u32_dpp v43, v43, v43 row_bcast:31 row_mask:0xc bank_mask:0xf
v_max_u32_dpp v44, v44, v44 row_bcast:31 row_mask:0xc bank_mask:0xf
v_max_u32_dpp v45, v45, v45 row_bcast:31 row_mask:0xc bank_mask:0xf
v_max_u32_dpp v46, v46, v46 row_bcast:31 row_mask:0xc bank_mask:0xf
v_readlane_b32 s76, v40, 63
v_readlane_b32 s77, v41, 63
v_readlane_b32 s78, v42, 63
v_readlane_b32 s79, v43, 63
v_readlane_b32 s80, v44, 63
v_readlane_b32 s81, v45, 63
v_add_lshl_u32 v40, v40, v4, 3
buffer_load_dwordx2 v[8:9], v40, s[16:19], s56 offen offset:0 sc1
s_max_u32 s77, s77, s76
s_max_u32 s78, s78, s77
s_max_u32 s79, s79, s78
s_max_u32 s80, s80, s79
s_max_u32 s81, s81, s80
v_max_u32 v41, s76, v41
v_max_u32 v42, s77, v42
v_max_u32 v43, s78, v43
v_max_u32 v44, s79, v44
v_max_u32 v45, s80, v45
v_max_u32 v46, s81, v46
v_add_lshl_u32 v41, v41, v4, 3
v_add_lshl_u32 v42, v42, v4, 3
v_add_lshl_u32 v43, v43, v4, 3
v_add_lshl_u32 v44, v44, v4, 3
v_add_lshl_u32 v45, v45, v4, 3
v_add_lshl_u32 v46, v46, v4, 3
buffer_load_dwordx2 v[10:11], v41, s[16:19], s56 offen offset:512 sc1
buffer_load_dwordx2 v[12:13], v42, s[16:19], s56 offen offset:1024 sc1
buffer_load_dwordx2 v[14:15], v43, s[16:19], s56 offen offset:1536 sc1
buffer_load_dwordx2 v[16:17], v44, s[16:19], s56 offen offset:2048 sc1
buffer_load_dwordx2 v[18:19], v45, s[16:19], s56 offen offset:2560 sc1
buffer_load_dwordx2 v[20:21], v46, s[16:19], s56 offen offset:3072 sc1
s_cmp_lg_u32 s74, 0
s_cbranch_scc1 K2_NY
s_mov_b32 s74, 1
s_mov_b32 s58, 3216550459
s_mov_b32 s59, 3216550459
s_waitcnt vmcnt(7)
s_barrier
ds_read_b64_tr_b16 v[128:129], v60 offset:0
ds_read_b64_tr_b16 v[130:131], v60 offset:1024
ds_read_b64_tr_b16 v[132:133], v61 offset:0
ds_read_b64_tr_b16 v[134:135], v61 offset:1024
ds_read_b64_tr_b16 v[136:137], v60 offset:4096
ds_read_b64_tr_b16 v[138:139], v60 offset:5120
ds_read_b64_tr_b16 v[140:141], v61 offset:4096
ds_read_b64_tr_b16 v[142:143], v61 offset:5120
s_waitcnt lgkmcnt(6)
v_mfma_f32_32x32x16_bf16 v[64:79], v[128:131], a[192:195], 0
ds_read_b64_tr_b16 v[144:145], v60 offset:8192
ds_read_b64_tr_b16 v[146:147], v60 offset:9216
s_waitcnt lgkmcnt(6)
v_mfma_f32_32x32x16_bf16 v[80:95], v[132:135], a[192:195], 0
ds_read_b64_tr_b16 v[148:149], v61 offset:8192
ds_read_b64_tr_b16 v[150:151], v61 offset:9216
s_waitcnt lgkmcnt(6)
v_mfma_f32_32x32x16_bf16 v[64:79], v[136:139], a[196:199], v[64:79]
ds_read_b64_tr_b16 v[152:153], v60 offset:12288
ds_read_b64_tr_b16 v[154:155], v60 offset:13312
s_waitcnt lgkmcnt(6)
v_mfma_f32_32x32x16_bf16 v[80:95], v[140:143], a[196:199], v[80:95]
ds_read_b64_tr_b16 v[156:157], v61 offset:12288
ds_read_b64_tr_b16 v[158:159], v61 offset:13312
s_waitcnt lgkmcnt(6)
v_mfma_f32_32x32x16_bf16 v[64:79], v[144:147], a[200:203], v[64:79]
ds_read_b64_tr_b16 v[128:129], v60 offset:16384
ds_read_b64_tr_b16 v[130:131], v60 offset:17408
s_waitcnt lgkmcnt(6)
v_mfma_f32_32x32x16_bf16 v[80:95], v[148:151], a[200:203], v[80:95]
ds_read_b64_tr_b16 v[132:133], v61 offset:16384
ds_read_b64_tr_b16 v[134:135], v61 offset:17408
s_waitcnt lgkmcnt(6)
v_mfma_f32_32x32x16_bf16 v[64:79], v[152:155], a[204:207], v[64:79]
ds_read_b64_tr_b16 v[136:137], v60 offset:20480
ds_read_b64_tr_b16 v[138:139], v60 offset:21504
s_waitcnt lgkmcnt(6)
v_mfma_f32_32x32x16_bf16 v[80:95], v[156:159], a[204:207], v[80:95]
ds_read_b64_tr_b16 v[140:141], v61 offset:20480
ds_read_b64_tr_b16 v[142:143], v61 offset:21504
s_waitcnt lgkmcnt(6)
v_mfma_f32_32x32x16_bf16 v[64:79], v[128:131], a[208:211], v[64:79]
ds_read_b64_tr_b16 v[144:145], v60 offset:24576
ds_read_b64_tr_b16 v[146:147], v60 offset:25600
s_waitcnt lgkmcnt(6)
v_mfma_f32_32x32x16_bf16 v[80:95], v[132:135], a[208:211], v[80:95]
ds_read_b64_tr_b16 v[148:149], v61 offset:24576
ds_read_b64_tr_b16 v[150:151], v61 offset:25600
s_waitcnt lgkmcnt(6)
v_mfma_f32_32x32x16_bf16 v[64:79], v[136:139], a[212:215], v[64:79]
ds_read_b64_tr_b16 v[152:153], v60 offset:28672
ds_read_b64_tr_b16 v[154:155], v60 offset:29696
s_waitcnt lgkmcnt(6)
v_mfma_f32_32x32x16_bf16 v[80:95], v[140:143], a[212:215], v[80:95]
ds_read_b64_tr_b16 v[156:157], v61 offset:28672
ds_read_b64_tr_b16 v[158:159], v61 offset:29696
s_waitcnt lgkmcnt(6)
v_mfma_f32_32x32x16_bf16 v[64:79], v[144:147], a[216:219], v[64:79]
ds_read_b64_tr_b16 v[128:129], v62 offset:0
ds_read_b64_tr_b16 v[130:131], v62 offset:1024
s_waitcnt lgkmcnt(6)
v_mfma_f32_32x32x16_bf16 v[80:95], v[148:151], a[216:219], v[80:95]
ds_read_b64_tr_b16 v[132:133], v63 offset:0
ds_read_b64_tr_b16 v[134:135], v63 offset:1024
s_waitcnt lgkmcnt(6)
v_mfma_f32_32x32x16_bf16 v[64:79], v[152:155], a[220:223], v[64:79]
ds_read_b64_tr_b16 v[136:137], v62 offset:4096
ds_read_b64_tr_b16 v[138:139], v62 offset:5120
s_waitcnt lgkmcnt(6)
v_mfma_f32_32x32x16_bf16 v[80:95], v[156:159], a[220:223], v[80:95]
ds_read_b64_tr_b16 v[140:141], v63 offset:4096
ds_read_b64_tr_b16 v[142:143], v63 offset:5120
s_waitcnt lgkmcnt(6)
v_mfma_f32_32x32x16_bf16 v[96:111], v[128:131], a[192:195], 0
ds_read_b64_tr_b16 v[144:145], v62 offset:8192
ds_read_b64_tr_b16 v[146:147], v62 offset:9216
s_waitcnt lgkmcnt(6)
v_mfma_f32_32x32x16_bf16 v[112:127], v[132:135], a[192:195], 0
ds_read_b64_tr_b16 v[148:149], v63 offset:8192
ds_read_b64_tr_b16 v[150:151], v63 offset:9216
s_waitcnt lgkmcnt(6)
v_mfma_f32_32x32x16_bf16 v[96:111], v[136:139], a[196:199], v[96:111]
ds_read_b64_tr_b16 v[152:153], v62 offset:12288
ds_read_b64_tr_b16 v[154:155], v62 offset:13312
v_mul_f32 v64, s58, v64
v_mul_f32 v65, s58, v65
v_mul_f32 v66, s58, v66
v_mul_f32 v67, s58, v67
s_waitcnt lgkmcnt(6)
v_mfma_f32_32x32x16_bf16 v[112:127], v[140:143], a[196:199], v[112:127]
ds_read_b64_tr_b16 v[156:157], v63 offset:12288
ds_read_b64_tr_b16 v[158:159], v63 offset:13312
v_mul_f32 v68, s58, v68
v_mul_f32 v69, s58, v69
v_mul_f32 v70, s58, v70
v_mul_f32 v71, s58, v71
s_waitcnt lgkmcnt(6)
v_mfma_f32_32x32x16_bf16 v[96:111], v[144:147], a[200:203], v[96:111]
ds_read_b64_tr_b16 v[128:129], v62 offset:16384
ds_read_b64_tr_b16 v[130:131], v62 offset:17408
v_mul_f32 v72, s58, v72
v_mul_f32 v73, s58, v73
v_mul_f32 v74, s58, v74
v_mul_f32 v75, s58, v75
s_waitcnt lgkmcnt(6)
v_mfma_f32_32x32x16_bf16 v[112:127], v[148:151], a[200:203], v[112:127]
ds_read_b64_tr_b16 v[132:133], v63 offset:16384
ds_read_b64_tr_b16 v[134:135], v63 offset:17408
v_mul_f32 v76, s58, v76
v_mul_f32 v77, s58, v77
v_mul_f32 v78, s58, v78
v_mul_f32 v79, s58, v79
s_waitcnt lgkmcnt(6)
v_mfma_f32_32x32x16_bf16 v[96:111], v[152:155], a[204:207], v[96:111]
ds_read_b64_tr_b16 v[136:137], v62 offset:20480
ds_read_b64_tr_b16 v[138:139], v62 offset:21504
v_accvgpr_write_b32 a0, v64
v_accvgpr_write_b32 a1, v65
v_accvgpr_write_b32 a2, v66
v_accvgpr_write_b32 a3, v67
s_waitcnt lgkmcnt(6)
v_mfma_f32_32x32x16_bf16 v[112:127], v[156:159], a[204:207], v[112:127]
ds_read_b64_tr_b16 v[140:141], v63 offset:20480
ds_read_b64_tr_b16 v[142:143], v63 offset:21504
v_accvgpr_write_b32 a4, v68
v_accvgpr_write_b32 a5, v69
v_accvgpr_write_b32 a6, v70
v_accvgpr_write_b32 a7, v71
s_waitcnt lgkmcnt(6)
v_mfma_f32_32x32x16_bf16 v[96:111], v[128:131], a[208:211], v[96:111]
ds_read_b64_tr_b16 v[144:145], v62 offset:24576
ds_read_b64_tr_b16 v[146:147], v62 offset:25600
v_accvgpr_write_b32 a8, v72
v_accvgpr_write_b32 a9, v73
v_accvgpr_write_b32 a10, v74
v_accvgpr_write_b32 a11, v75
s_waitcnt lgkmcnt(6)
v_mfma_f32_32x32x16_bf16 v[112:127], v[132:135], a[208:211], v[112:127]
ds_read_b64_tr_b16 v[148:149], v63 offset:24576
ds_read_b64_tr_b16 v[150:151], v63 offset:25600
v_accvgpr_write_b32 a12, v76
v_accvgpr_write_b32 a13, v77
v_accvgpr_write_b32 a14, v78
v_accvgpr_write_b32 a15, v79
s_waitcnt lgkmcnt(6)
v_mfma_f32_32x32x16_bf16 v[96:111], v[136:139], a[212:215], v[96:111]
ds_read_b64_tr_b16 v[152:153], v62 offset:28672
ds_read_b64_tr_b16 v[154:155], v62 offset:29696
v_mul_f32 v80, s58, v80
v_mul_f32 v81, s58, v81
v_mul_f32 v82, s58, v82
v_mul_f32 v83, s58, v83
s_waitcnt lgkmcnt(6)
v_mfma_f32_32x32x16_bf16 v[112:127], v[140:143], a[212:215], v[112:127]
ds_read_b64_tr_b16 v[156:157], v63 offset:28672
ds_read_b64_tr_b16 v[158:159], v63 offset:29696
v_mul_f32 v84, s58, v84
v_mul_f32 v85, s58, v85
v_mul_f32 v86, s58, v86
v_mul_f32 v87, s58, v87
s_waitcnt lgkmcnt(6)
v_mfma_f32_32x32x16_bf16 v[96:111], v[144:147], a[216:219], v[96:111]
v_mul_f32 v88, s58, v88
v_mul_f32 v89, s58, v89
v_mul_f32 v90, s58, v90
v_mul_f32 v91, s58, v91
s_waitcnt lgkmcnt(4)
v_mfma_f32_32x32x16_bf16 v[112:127], v[148:151], a[216:219], v[112:127]
v_mul_f32 v92, s58, v92
v_mul_f32 v93, s58, v93
v_mul_f32 v94, s58, v94
v_mul_f32 v95, s58, v95
s_waitcnt lgkmcnt(2)
v_mfma_f32_32x32x16_bf16 v[96:111], v[152:155], a[220:223], v[96:111]
v_accvgpr_write_b32 a16, v80
v_accvgpr_write_b32 a17, v81
v_accvgpr_write_b32 a18, v82
v_accvgpr_write_b32 a19, v83
s_waitcnt lgkmcnt(0)
v_mfma_f32_32x32x16_bf16 v[112:127], v[156:159], a[220:223], v[112:127]
v_accvgpr_write_b32 a20, v84
v_accvgpr_write_b32 a21, v85
v_accvgpr_write_b32 a22, v86
v_accvgpr_write_b32 a23, v87
v_accvgpr_write_b32 a24, v88
v_accvgpr_write_b32 a25, v89
v_accvgpr_write_b32 a26, v90
v_accvgpr_write_b32 a27, v91
v_accvgpr_write_b32 a28, v92
v_accvgpr_write_b32 a29, v93
v_accvgpr_write_b32 a30, v94
v_accvgpr_write_b32 a31, v95
v_pk_mul_f32 v[96:97], v[96:97], s[58:59]
v_pk_mul_f32 v[98:99], v[98:99], s[58:59]
v_pk_mul_f32 v[100:101], v[100:101], s[58:59]
v_pk_mul_f32 v[102:103], v[102:103], s[58:59]
v_pk_mul_f32 v[104:105], v[104:105], s[58:59]
v_pk_mul_f32 v[106:107], v[106:107], s[58:59]
v_pk_mul_f32 v[108:109], v[108:109], s[58:59]
v_pk_mul_f32 v[110:111], v[110:111], s[58:59]
v_accvgpr_write_b32 a32, v96
v_accvgpr_write_b32 a33, v97
v_accvgpr_write_b32 a34, v98
v_accvgpr_write_b32 a35, v99
v_accvgpr_write_b32 a36, v100
v_accvgpr_write_b32 a37, v101
v_accvgpr_write_b32 a38, v102
v_accvgpr_write_b32 a39, v103
v_accvgpr_write_b32 a40, v104
v_accvgpr_write_b32 a41, v105
v_accvgpr_write_b32 a42, v106
v_accvgpr_write_b32 a43, v107
v_accvgpr_write_b32 a44, v108
v_accvgpr_write_b32 a45, v109
v_accvgpr_write_b32 a46, v110
v_accvgpr_write_b32 a47, v111
v_pk_mul_f32 v[112:113], v[112:113], s[58:59]
v_pk_mul_f32 v[114:115], v[114:115], s[58:59]
v_pk_mul_f32 v[116:117], v[116:117], s[58:59]
v_pk_mul_f32 v[118:119], v[118:119], s[58:59]
v_pk_mul_f32 v[120:121], v[120:121], s[58:59]
v_pk_mul_f32 v[122:123], v[122:123], s[58:59]
v_pk_mul_f32 v[124:125], v[124:125], s[58:59]
v_pk_mul_f32 v[126:127], v[126:127], s[58:59]
v_accvgpr_write_b32 a48, v112
v_accvgpr_write_b32 a49, v113
v_accvgpr_write_b32 a50, v114
v_accvgpr_write_b32 a51, v115
v_accvgpr_write_b32 a52, v116
v_accvgpr_write_b32 a53, v117
v_accvgpr_write_b32 a54, v118
v_accvgpr_write_b32 a55, v119
v_accvgpr_write_b32 a56, v120
v_accvgpr_write_b32 a57, v121
v_accvgpr_write_b32 a58, v122
v_accvgpr_write_b32 a59, v123
v_accvgpr_write_b32 a60, v124
v_accvgpr_write_b32 a61, v125
v_accvgpr_write_b32 a62, v126
v_accvgpr_write_b32 a63, v127
s_waitcnt vmcnt(0)
K2_YD:
v_mov_b32 v27, 1
v_lshrrev_b32 v160, 17, v8
v_lshrrev_b32 v161, 17, v10
v_lshrrev_b32 v162, 17, v12
v_lshrrev_b32 v163, 17, v14
v_lshrrev_b32 v164, 17, v16
v_lshrrev_b32 v165, 17, v18
v_lshrrev_b32 v166, 17, v20
s_mov_b32 s59, 524288
s_cmp_lg_u32 s30, 3
s_cselect_b32 s18, 0, s18
buffer_load_dwordx4 v[148:151], v1, s[16:19], s59 offen sc1
buffer_load_dwordx4 v[156:159], v1, s[16:19], s59 offen offset:1024 sc1
s_mov_b32 s18, 4139648
s_mov_b64 exec, s[60:61]
ds_add_rtn_u32 v168, v160, v27 offset:30240
s_mov_b64 exec, s[62:63]
ds_add_rtn_u32 v169, v161, v27 offset:30240
s_mov_b64 exec, s[64:65]
ds_add_rtn_u32 v170, v162, v27 offset:30240
s_mov_b64 exec, s[66:67]
ds_add_rtn_u32 v171, v163, v27 offset:30240
s_mov_b64 exec, s[68:69]
ds_add_rtn_u32 v172, v164, v27 offset:30240
s_mov_b64 exec, s[70:71]
ds_add_rtn_u32 v173, v165, v27 offset:30240
s_mov_b64 exec, s[72:73]
ds_add_rtn_u32 v174, v166, v27 offset:30240
s_mov_b64 exec, -1
s_movk_i32 s56, 656
s_mov_b32 s57, 10496
v_mov_b32 v51, 0
v_bfrev_b32 v53, 2
v_dot2_u32_u16 v176, v9, s50, 0
v_mad_u32_u24 v184, v160, s56, v51
v_dot2_u32_u16 v177, v11, s50, 0
v_mad_u32_u24 v185, v161, s56, v51
v_dot2_u32_u16 v178, v13, s50, 0
v_mad_u32_u24 v186, v162, s56, v51
v_dot2_u32_u16 v179, v15, s50, 0
v_mad_u32_u24 v187, v163, s56, v51
v_dot2_u32_u16 v180, v17, s50, 0
v_mad_u32_u24 v188, v164, s56, v51
v_dot2_u32_u16 v181, v19, s50, 0
v_mad_u32_u24 v189, v165, s56, v51
v_dot2_u32_u16 v182, v21, s50, 0
v_mad_u32_u24 v190, v166, s56, v51
v_cmp_gt_u16 s[76:77], s57, v184
v_cmp_gt_u16 s[78:79], s57, v185
v_cmp_gt_u16 s[80:81], s57, v186
v_cmp_gt_u16 s[82:83], s57, v187
s_and_b64 s[76:77], s[76:77], s[60:61]
s_and_b64 s[78:79], s[78:79], s[62:63]
s_and_b64 s[80:81], s[80:81], s[64:65]
s_and_b64 s[82:83], s[82:83], s[66:67]
v_cndmask_b32 v176, v53, v176, s[76:77]
buffer_load_dword v50, v176, s[8:11], 0 offen
v_cndmask_b32 v177, v53, v177, s[78:79]
buffer_load_dword v50, v177, s[8:11], 0 offen
v_cndmask_b32 v178, v53, v178, s[80:81]
buffer_load_dword v50, v178, s[8:11], 0 offen
v_cndmask_b32 v179, v53, v179, s[82:83]
buffer_load_dword v50, v179, s[8:11], 0 offen
v_cmp_gt_u16 s[76:77], s57, v188
v_cmp_gt_u16 s[78:79], s57, v189
v_cmp_gt_u16 s[80:81], s57, v190
s_and_b64 s[76:77], s[76:77], s[68:69]
s_and_b64 s[78:79], s[78:79], s[70:71]
s_and_b64 s[80:81], s[80:81], s[72:73]
v_cndmask_b32 v180, v53, v180, s[76:77]
buffer_load_dword v50, v180, s[8:11], 0 offen
v_cndmask_b32 v181, v53, v181, s[78:79]
buffer_load_dword v50, v181, s[8:11], 0 offen
v_cndmask_b32 v182, v53, v182, s[80:81]
buffer_load_dword v50, v182, s[8:11], 0 offen
s_mov_b64 exec, -1
v_add_u32 v29, 30752, v28
s_waitcnt lgkmcnt(0)
s_barrier
ds_read_b64 v[36:37], v28 offset:30240
s_waitcnt lgkmcnt(0)
v_add_u32 v38, v36, v37
v_mov_b32 v39, v38
v_and_b32 v2, 48, v4
v_and_b32 v3, 7, v4
v_add_u32_dpp v39, v39, v39 row_shr:1 row_mask:0xf bank_mask:0xf bound_ctrl:0
v_lshl_add_u32 v3, v3, 1, v2
v_mul_u32_u24 v2, 496, v6
v_add_u32_dpp v39, v39, v39 row_shr:2 row_mask:0xf bank_mask:0xf bound_ctrl:0
v_lshl_add_u32 v2, v5, 9, v2
v_cmp_lt_u32 s[82:83], 0, v38
v_add_u32_dpp v39, v39, v39 row_shr:4 row_mask:0xf bank_mask:0xf bound_ctrl:0
v_mov_b32 v24, 0
v_mov_b32 v25, 0
v_add_u32_dpp v39, v39, v39 row_shr:8 row_mask:0xf bank_mask:0xf bound_ctrl:0
v_mov_b32 v26, 0
v_mov_b32 v220, 0
v_add_u32_dpp v39, v39, v39 row_bcast:15 row_mask:0xa bank_mask:0xf
v_mov_b32 v221, 0
v_mov_b32 v222, 0
v_add_u32_dpp v39, v39, v39 row_bcast:31 row_mask:0xc bank_mask:0xf
v_sub_u32 v56, v39, v38
v_add_u32 v56, 98, v56
v_add_u32 v57, v56, v36
ds_write_b64 v28, v[56:57] offset:30752
ds_read2_b32 v[58:59], v29 offset0:7 offset1:8
ds_read_b32 v40, v160 offset:30752
ds_read_b32 v41, v161 offset:30752
ds_read_b32 v42, v162 offset:30752
ds_read_b32 v43, v163 offset:30752
ds_read_b32 v44, v164 offset:30752
ds_read_b32 v45, v165 offset:30752
ds_read_b32 v46, v166 offset:30752
v_readlane_b32 s35, v39, 63
s_mov_b32 s36, 0
s_cmp_eq_u32 s35, 0
s_cbranch_scc1 K2_K0
s_add_u32 s56, s35, 98
s_waitcnt lgkmcnt(7)
v_sub_u32 v60, v58, v56
v_sub_u32 v61, v59, v57
v_cmp_gt_u32 s[76:77], 31, v60
v_cmp_gt_u32 s[78:79], s56, v58
v_cmp_gt_u32 s[80:81], 31, v61
v_cmp_gt_u32 vcc, s56, v59
s_waitcnt vmcnt(7)
v_xor_b32 v148, s39, v148
v_xor_b32 v149, s38, v149
v_xor_b32 v150, s39, v150
v_xor_b32 v151, s38, v151
s_and_b64 s[76:77], s[76:77], s[78:79]
s_and_b64 vcc, vcc, s[80:81]
s_or_b64 vcc, vcc, s[76:77]
s_and_b32 vcc_hi, vcc_hi, 0x1ffff
s_cmp_lg_u64 vcc, 0
s_cbranch_scc1 K2_PAD
K2_PADRET:
s_add_u32 s80, s35, 31
s_flbit_i32_b64 s56, s[82:83]
s_lshr_b32 s80, s80, 5
s_sub_u32 s56, 63, s56
s_lshl_b32 s58, s80, 5
s_add_u32 s59, s35, 98
s_sub_u32 s58, s58, s35
v_readlane_b32 s57, v37, s56
v_cmp_gt_u32 vcc, s58, v4
v_add_lshl_u32 v56, v4, s59, 4
v_mov_b32 v60, 0
v_mov_b32 v61, 0
v_mov_b32 v63, 0
s_cmp_lg_u32 s57, 0
s_addc_u32 s56, s56, s56
s_lshl_b32 s57, s56, 19
s_bitset1_b32 s57, 15
v_mov_b32 v62, s57
s_lshr_b32 s56, s80, 2
s_mov_b64 exec, vcc
ds_write_b128 v56, v[60:63]
s_mov_b64 exec, -1
v_xor_b32 v156, s39, v156
v_xor_b32 v157, s38, v157
v_xor_b32 v158, s39, v158
v_xor_b32 v159, s38, v159
v_or3_b32 v148, v148, v149, v150
v_or3_b32 v156, v156, v157, v158
v_or3_b32 v148, v148, v151, v159
v_or_b32 v148, v148, v156
v_cmp_ne_u32 vcc, 0, v148
s_waitcnt lgkmcnt(1)
v_add_lshl_u32 v160, v40, v168, 4
v_add_lshl_u32 v161, v41, v169, 4
v_add_lshl_u32 v162, v42, v170, 4
v_add_lshl_u32 v163, v43, v171, 4
v_add_lshl_u32 v164, v44, v172, 4
v_add_lshl_u32 v165, v45, v173, 4
v_add_lshl_u32 v166, v46, v174, 4
s_mov_b64 exec, s[60:61]
ds_write_b64 v160, v[8:9] offset:8
s_mov_b64 exec, s[62:63]
ds_write_b64 v161, v[10:11] offset:8
s_mov_b64 exec, s[64:65]
ds_write_b64 v162, v[12:13] offset:8
s_mov_b64 exec, s[66:67]
ds_write_b64 v163, v[14:15] offset:8
s_mov_b64 exec, s[68:69]
ds_write_b64 v164, v[16:17] offset:8
s_mov_b64 exec, s[70:71]
ds_write_b64 v165, v[18:19] offset:8
s_mov_b64 exec, s[72:73]
ds_write_b64 v166, v[20:21] offset:8
s_mov_b64 exec, -1
s_and_b32 s57, s80, 3
s_mul_i32 s58, s56, s30
s_min_u32 s59, s30, s57
s_add_u32 s58, s58, s59
s_cmp_lt_u32 s30, s57
s_addc_u32 s36, s56, 0
s_lshl_b32 s56, s58, 9
s_add_u32 s56, s56, 1568
s_lshl_b32 s57, s36, 9
s_add_u32 s67, s56, s57
s_sub_u32 s43, s36, 1
s_sub_u32 s44, s36, 3
s_lshl2_add_u32 s57, s31, s30
s_cmp_eq_u32 s57, 3
s_cselect_b64 vcc, vcc, 0
s_movk_i32 s41, 20000
v_lshl_add_u32 v228, v5, 4, s56
v_lshl_add_u32 v239, v4, 4, s56
v_lshl_add_u32 v229, v3, 3, s56
v_add_u32 v2, s56, v2
v_mov_b32 v3, 35360
s_mov_b32 s58, -1
s_mov_b32 s59, 0
s_cmp_eq_u64 vcc, 0
v_cndmask_b32 v236, v228, v3, s[58:59]
s_cbranch_scc0 K2_FW2
K2_FD:
s_add_u32 s81, s80, 3
s_lshr_b32 s81, s81, 2
s_cmp_lt_u32 s36, s81
s_cselect_b64 vcc, -1, 0
s_cmp_eq_u32 s36, 0
s_waitcnt lgkmcnt(0)
s_barrier
s_cbranch_scc1 K2_K0
ds_read_b32 v8, v239 offset:8
ds_read_u16 v12, v229 offset:8
ds_read_b32 v9, v228 offset:12
ds_read_u16 v16, v229 offset:520
ds_read_b32 v241, v239 offset:1032
ds_read_u16 v247, v2 offset:10
ds_read_u16 v208, v229 offset:1032
ds_read_b32 v219, v228 offset:524
s_cbranch_vccnz K2_SF
K2_SD:
s_mov_b32 m0, s46
s_waitcnt lgkmcnt(7)
v_mad_u32_u16 v20, v8, 6, 0
buffer_load_short_d16_hi v24, v20, s[12:15], 0 offen offset:0
buffer_load_short_d16_hi v25, v20, s[12:15], 0 offen offset:2
buffer_load_short_d16_hi v26, v20, s[12:15], 0 offen offset:4
s_waitcnt lgkmcnt(5)
v_lshlrev_b32 v12, 8, v12
v_dot2_u32_u16 v255, v9, s50, v238
s_nop 0
v_add_u32_dpp v176, v12, v200 row_newbcast:0 row_mask:0xf bank_mask:0xf
buffer_load_dwordx4 v176, s[4:7], 0 offen offset:0 sc1 lds
v_add_u32_dpp v177, v12, v201 row_newbcast:1 row_mask:0xf bank_mask:0xf
buffer_load_dwordx4 v177, s[4:7], 0 offen offset:1024 sc1 lds
v_add_u32_dpp v178, v12, v202 row_newbcast:2 row_mask:0xf bank_mask:0xf
buffer_load_dwordx4 v178, s[4:7], 0 offen offset:2048 sc1 lds
v_add_u32_dpp v179, v12, v203 row_newbcast:3 row_mask:0xf bank_mask:0xf
buffer_load_dwordx4 v179, s[4:7], 0 offen offset:3072 sc1 lds
s_mov_b32 m0, s47
v_add_u32_dpp v180, v12, v204 row_newbcast:4 row_mask:0xf bank_mask:0xf
buffer_load_dwordx4 v180, s[4:7], 0 offen offset:0 sc1 lds
v_add_u32_dpp v181, v12, v205 row_newbcast:5 row_mask:0xf bank_mask:0xf
buffer_load_dwordx4 v181, s[4:7], 0 offen offset:1024 sc1 lds
v_add_u32_dpp v182, v12, v206 row_newbcast:6 row_mask:0xf bank_mask:0xf
buffer_load_dwordx4 v182, s[4:7], 0 offen offset:2048 sc1 lds
v_add_u32_dpp v183, v12, v207 row_newbcast:7 row_mask:0xf bank_mask:0xf
buffer_load_dwordx4 v183, s[4:7], 0 offen offset:3072 sc1 lds
buffer_load_dwordx4 a[224:227], v255, s[8:11], 0 offen
s_cmp_lt_u32 s36, s81
s_cbranch_scc1 K2_SE
K2_SF:
s_waitcnt lgkmcnt(3)
v_mad_u32_u16 v10, v8, 2, 0 op_sel:[1,0,0,0]
v_mad_u32_u16 v11, v241, 2, 0 op_sel:[1,0,0,0]
v_lshlrev_b32 v16, 8, v16
ds_read_b96 v[28:30], v10 offset:0
ds_read_b96 v[216:218], v11 offset:0
v_cmp_gt_u32 vcc, s36, v5
v_mov_b32 v3, 0xffff
s_mov_b32 s37, -1
s_mov_b32 s39, -2
s_movk_i32 s65, 0x3F80
s_mov_b32 s66, 1.0
s_waitcnt lgkmcnt(0)
v_cndmask_b32 v247, v3, v247, vcc
v_mov_b32 v64, 0
v_readlane_b32 s41, v247, 0
s_add_u32 s57, s41, 56
s_mul_i32 s58, s41, 33
v_cmp_lt_u32 vcc, s57, v247
s_lshr_b32 s58, s58, 1
v_mad_u32_u24 v234, v235, s58, v243
v_mad_u32_u24 v255, v235, s58, v244
s_sub_i32 s59, 0, s41
s_ff1_i32_b32 s56, vcc_hi
s_sub_u32 s40, s56, 1
s_mov_b32 s38, s40
v_readlane_b32 s68, v247, s56
v_mad_i32_i24 v236, v235, s59, v236
v_add_u32 v231, s59, v231
ds_read_b64_tr_b16 a[144:145], v234 offset:0
ds_read_b64_tr_b16 a[146:147], v255 offset:0
ds_read_b64_tr_b16 a[148:149], v234 offset:64
ds_read_b64_tr_b16 a[150:151], v255 offset:64
ds_read_b64_tr_b16 a[152:153], v234 offset:128
ds_read_b64_tr_b16 a[154:155], v255 offset:128
ds_read_b64_tr_b16 a[156:157], v234 offset:192
ds_read_b64_tr_b16 a[158:159], v255 offset:192
s_cmp_eq_u32 s74, 1
s_cbranch_scc0 K2_WS
s_mov_b32 s74, 2
s_mov_b32 s76, 3216550459
s_mov_b32 s77, 3216550459
v_accvgpr_read_b32 v128, a128
v_accvgpr_read_b32 v129, a129
v_accvgpr_read_b32 v130, a130
v_accvgpr_read_b32 v131, a131
v_lshlrev_b32 v132, 16, v128
v_and_b32 v133, 0xffff0000, v128
v_lshlrev_b32 v134, 16, v129
v_and_b32 v135, 0xffff0000, v129
v_lshlrev_b32 v136, 16, v130
v_and_b32 v137, 0xffff0000, v130
v_lshlrev_b32 v138, 16, v131
v_and_b32 v139, 0xffff0000, v131
v_pk_mul_f32 v[132:133], v[132:133], s[76:77]
v_pk_mul_f32 v[134:135], v[134:135], s[76:77]
v_pk_mul_f32 v[136:137], v[136:137], s[76:77]
v_pk_mul_f32 v[138:139], v[138:139], s[76:77]
v_cvt_pk_bf16_f32 v128, v132, v133
v_cvt_pk_bf16_f32 v129, v134, v135
v_cvt_pk_bf16_f32 v130, v136, v137
v_cvt_pk_bf16_f32 v131, v138, v139
v_accvgpr_write_b32 a128, v128
v_accvgpr_write_b32 a129, v129
v_accvgpr_write_b32 a130, v130
v_accvgpr_write_b32 a131, v131
v_accvgpr_read_b32 v128, a132
v_accvgpr_read_b32 v129, a133
v_accvgpr_read_b32 v130, a134
v_accvgpr_read_b32 v131, a135
v_lshlrev_b32 v132, 16, v128
v_and_b32 v133, 0xffff0000, v128
v_lshlrev_b32 v134, 16, v129
v_and_b32 v135, 0xffff0000, v129
v_lshlrev_b32 v136, 16, v130
v_and_b32 v137, 0xffff0000, v130
v_lshlrev_b32 v138, 16, v131
v_and_b32 v139, 0xffff0000, v131
v_pk_mul_f32 v[132:133], v[132:133], s[76:77]
v_pk_mul_f32 v[134:135], v[134:135], s[76:77]
v_pk_mul_f32 v[136:137], v[136:137], s[76:77]
v_pk_mul_f32 v[138:139], v[138:139], s[76:77]
v_cvt_pk_bf16_f32 v128, v132, v133
v_cvt_pk_bf16_f32 v129, v134, v135
v_cvt_pk_bf16_f32 v130, v136, v137
v_cvt_pk_bf16_f32 v131, v138, v139
v_accvgpr_write_b32 a132, v128
v_accvgpr_write_b32 a133, v129
v_accvgpr_write_b32 a134, v130
v_accvgpr_write_b32 a135, v131
v_accvgpr_read_b32 v128, a136
v_accvgpr_read_b32 v129, a137
v_accvgpr_read_b32 v130, a138
v_accvgpr_read_b32 v131, a139
v_lshlrev_b32 v132, 16, v128
v_and_b32 v133, 0xffff0000, v128
v_lshlrev_b32 v134, 16, v129
v_and_b32 v135, 0xffff0000, v129
v_lshlrev_b32 v136, 16, v130
v_and_b32 v137, 0xffff0000, v130
v_lshlrev_b32 v138, 16, v131
v_and_b32 v139, 0xffff0000, v131
v_pk_mul_f32 v[132:133], v[132:133], s[76:77]
v_pk_mul_f32 v[134:135], v[134:135], s[76:77]
v_pk_mul_f32 v[136:137], v[136:137], s[76:77]
v_pk_mul_f32 v[138:139], v[138:139], s[76:77]
v_cvt_pk_bf16_f32 v128, v132, v133
v_cvt_pk_bf16_f32 v129, v134, v135
v_cvt_pk_bf16_f32 v130, v136, v137
v_cvt_pk_bf16_f32 v131, v138, v139
v_accvgpr_write_b32 a136, v128
v_accvgpr_write_b32 a137, v129
v_accvgpr_write_b32 a138, v130
v_accvgpr_write_b32 a139, v131
v_accvgpr_read_b32 v128, a140
v_accvgpr_read_b32 v129, a141
v_accvgpr_read_b32 v130, a142
v_accvgpr_read_b32 v131, a143
v_lshlrev_b32 v132, 16, v128
v_and_b32 v133, 0xffff0000, v128
v_lshlrev_b32 v134, 16, v129
v_and_b32 v135, 0xffff0000, v129
v_lshlrev_b32 v136, 16, v130
v_and_b32 v137, 0xffff0000, v130
v_lshlrev_b32 v138, 16, v131
v_and_b32 v139, 0xffff0000, v131
v_pk_mul_f32 v[132:133], v[132:133], s[76:77]
v_pk_mul_f32 v[134:135], v[134:135], s[76:77]
v_pk_mul_f32 v[136:137], v[136:137], s[76:77]
v_pk_mul_f32 v[138:139], v[138:139], s[76:77]
v_cvt_pk_bf16_f32 v128, v132, v133
v_cvt_pk_bf16_f32 v129, v134, v135
v_cvt_pk_bf16_f32 v130, v136, v137
v_cvt_pk_bf16_f32 v131, v138, v139
v_accvgpr_write_b32 a140, v128
v_accvgpr_write_b32 a141, v129
v_accvgpr_write_b32 a142, v130
v_accvgpr_write_b32 a143, v131
v_mul_f32 v224, 3207688728, v224
v_mul_f32 v225, 3207688728, v225
v_mul_f32 v226, 3207688728, v226
v_mul_f32 v227, 3207688728, v227
K2_WS:
v_mov_b32 v65, 0
v_mov_b32 v66, 0
v_mov_b32 v67, 0
v_mov_b32 v68, 0
v_mov_b32 v69, 0
v_mov_b32 v70, 0
v_mov_b32 v71, 0
v_mov_b32 v72, 0
v_mov_b32 v73, 0
v_mov_b32 v74, 0
v_mov_b32 v75, 0
v_mov_b32 v76, 0
v_mov_b32 v77, 0
v_mov_b32 v78, 0
v_mov_b32 v79, 0
v_mov_b32 v80, 0
v_mov_b32 v81, 0
v_mov_b32 v82, 0
v_mov_b32 v83, 0
v_mov_b32 v84, 0
v_mov_b32 v85, 0
v_mov_b32 v86, 0
v_mov_b32 v87, 0
v_mov_b32 v88, 0
v_mov_b32 v89, 0
v_mov_b32 v90, 0
v_mov_b32 v91, 0
v_mov_b32 v92, 0
v_mov_b32 v93, 0
v_mov_b32 v94, 0
v_mov_b32 v95, 0
v_mov_b32 v96, 0
v_mov_b32 v97, 0
v_mov_b32 v98, 0
v_mov_b32 v99, 0
v_mov_b32 v100, 0
v_mov_b32 v101, 0
v_mov_b32 v102, 0
v_mov_b32 v103, 0
v_mov_b32 v104, 0
v_mov_b32 v105, 0
v_mov_b32 v106, 0
v_mov_b32 v107, 0
v_mov_b32 v108, 0
v_mov_b32 v109, 0
v_mov_b32 v110, 0
v_mov_b32 v111, 0
v_mov_b32 v112, 0
v_mov_b32 v113, 0
v_mov_b32 v114, 0
v_mov_b32 v115, 0
v_mov_b32 v116, 0
v_mov_b32 v117, 0
v_mov_b32 v118, 0
v_mov_b32 v119, 0
v_mov_b32 v120, 0
v_mov_b32 v121, 0
v_mov_b32 v122, 0
v_mov_b32 v123, 0
v_mov_b32 v124, 0
v_mov_b32 v125, 0
v_mov_b32 v126, 0
v_mov_b32 v127, 0
v_mov_b32 v128, 0
v_mov_b32 v129, 0
v_mov_b32 v130, 0
v_mov_b32 v131, 0
v_mov_b32 v132, 0
v_mov_b32 v133, 0
v_mov_b32 v134, 0
v_mov_b32 v135, 0
v_mov_b32 v136, 0
v_mov_b32 v137, 0
v_mov_b32 v138, 0
v_mov_b32 v139, 0
v_mov_b32 v140, 0
v_mov_b32 v141, 0
v_mov_b32 v142, 0
v_mov_b32 v143, 0
v_mov_b32 v144, 0
v_mov_b32 v145, 0
v_mov_b32 v146, 0
v_mov_b32 v147, 0
v_mov_b32 v148, 0
v_mov_b32 v149, 0
v_mov_b32 v150, 0
v_mov_b32 v151, 0
v_mov_b32 v152, 0
v_mov_b32 v153, 0
v_mov_b32 v154, 0
v_mov_b32 v155, 0
v_mov_b32 v156, 0
v_mov_b32 v157, 0
v_mov_b32 v158, 0
v_mov_b32 v159, 0
v_accvgpr_write_b32 a236, 0
v_accvgpr_write_b32 a237, 0
v_accvgpr_write_b32 a238, 0
v_accvgpr_write_b32 a239, 0
v_accvgpr_write_b32 a240, 0
v_accvgpr_write_b32 a241, 0
v_accvgpr_write_b32 a242, 0
v_accvgpr_write_b32 a243, 0
s_cmp_lt_u32 s36, s81
s_cbranch_scc1 K2_SD
K2_SE:
s_waitcnt vmcnt(9)
v_sub_f32 v248, v28, v24
v_sub_f32 v249, v29, v25
v_sub_f32 v250, v30, v26
v_mul_f32 v251, v248, v248
v_cvt_pk_bf16_f32 v248, v248, v249
v_fmac_f32 v251, v249, v249
v_cvt_pk_bf16_f32 v249, v250, 1.0
v_fmac_f32 v251, v250, v250
v_cvt_pk_bf16_f32 v251, v251, v251
v_cmpx_gt_u32 vcc, s67, v239
v_cmpx_le_i16 vcc, 0, v8
ds_write_b64 v239, v[248:249] offset:0
ds_write_b16 v239, v251 offset:8
s_mov_b64 exec, -1
s_sub_u32 s67, s67, 1024
s_cmp_gt_u32 s36, 1
s_cselect_b32 s6, s54, 0
s_cselect_b32 s10, s55, 0
s_mov_b32 m0, s48
v_add_u32_dpp v176, v16, v200 row_newbcast:0 row_mask:0xf bank_mask:0xf
buffer_load_dwordx4 v176, s[4:7], 0 offen offset:0 sc1 lds
v_add_u32_dpp v177, v16, v201 row_newbcast:1 row_mask:0xf bank_mask:0xf
buffer_load_dwordx4 v177, s[4:7], 0 offen offset:1024 sc1 lds
v_add_u32_dpp v178, v16, v202 row_newbcast:2 row_mask:0xf bank_mask:0xf
buffer_load_dwordx4 v178, s[4:7], 0 offen offset:2048 sc1 lds
v_add_u32_dpp v179, v16, v203 row_newbcast:3 row_mask:0xf bank_mask:0xf
buffer_load_dwordx4 v179, s[4:7], 0 offen offset:3072 sc1 lds
s_mov_b32 m0, s49
v_add_u32_dpp v180, v16, v204 row_newbcast:4 row_mask:0xf bank_mask:0xf
buffer_load_dwordx4 v180, s[4:7], 0 offen offset:0 sc1 lds
v_add_u32_dpp v181, v16, v205 row_newbcast:5 row_mask:0xf bank_mask:0xf
buffer_load_dwordx4 v181, s[4:7], 0 offen offset:1024 sc1 lds
v_add_u32_dpp v182, v16, v206 row_newbcast:6 row_mask:0xf bank_mask:0xf
buffer_load_dwordx4 v182, s[4:7], 0 offen offset:2048 sc1 lds
v_add_u32_dpp v183, v16, v207 row_newbcast:7 row_mask:0xf bank_mask:0xf
buffer_load_dwordx4 v183, s[4:7], 0 offen offset:3072 sc1 lds
v_mad_u32_u16 v20, v241, 6, 0
buffer_load_short_d16_hi v220, v20, s[12:15], 0 offen offset:0
buffer_load_short_d16_hi v221, v20, s[12:15], 0 offen offset:2
buffer_load_short_d16_hi v222, v20, s[12:15], 0 offen offset:4
ds_read_b128 v[212:215], v228
s_waitcnt vmcnt(12)
ds_read_b128 a[160:163], v192
ds_read_b128 a[164:167], v193
ds_read_b128 a[168:171], v194
ds_read_b128 a[172:175], v195
ds_read_b128 a[176:179], v196
ds_read_b128 a[180:183], v197
ds_read_b128 a[184:187], v198
ds_read_b128 a[188:191], v199
s_waitcnt lgkmcnt(0)
v_mfma_f32_32x32x16_bf16 v[0:15], a[160:163], a[248:251], 0
ds_write_b64 v233, a[244:245]
v_mad_u32_u16 v234, v214, v235, v236 op_sel:[1,0,0,0]
v_dot2_u32_u16 v255, v219, s50, v238
v_mad_u32_u16 v232, v214, 1, v231 op_sel:[1,0,0,0]
v_mfma_f32_32x32x16_bf16 v[16:31], a[168:171], a[248:251], 0
s_cmp_lt_i32 s37, s44
ds_read_b128 a[232:235], v234
ds_write_b64 v232, v[212:213]
buffer_load_dwordx4 a[228:231], v255, s[8:11], 0 offen
v_mfma_f32_32x32x16_bf16 v[0:15], a[164:167], a[252:255], v[0:15]
s_cselect_b32 s6, s54, 0
v_lshlrev_b32 v208, 8, v208
v_mfma_f32_32x32x16_bf16 v[16:31], a[172:175], a[252:255], v[16:31]
s_cselect_b32 s10, s55, 0
s_mov_b32 m0, s46
v_add_u32_dpp v176, v208, v200 row_newbcast:0 row_mask:0xf bank_mask:0xf
buffer_load_dwordx4 v176, s[4:7], 0 offen offset:0 sc1 lds
v_add_u32_dpp v177, v208, v201 row_newbcast:1 row_mask:0xf bank_mask:0xf
v_add_u32 v236, v237, v236
buffer_load_dwordx4 v177, s[4:7], 0 offen offset:1024 sc1 lds
v_add_u32_dpp v178, v208, v202 row_newbcast:2 row_mask:0xf bank_mask:0xf
buffer_load_dwordx4 v178, s[4:7], 0 offen offset:2048 sc1 lds
v_add_u32_dpp v179, v208, v203 row_newbcast:3 row_mask:0xf bank_mask:0xf
buffer_load_dwordx4 v179, s[4:7], 0 offen offset:3072 sc1 lds
s_waitcnt vmcnt(16)
v_mfma_f32_32x32x16_bf16 v[0:15], a[224:227], a[128:131], v[0:15]
s_mov_b32 m0, s47
v_add_u32_dpp v180, v208, v204 row_newbcast:4 row_mask:0xf bank_mask:0xf
v_mfma_f32_32x32x16_bf16 v[16:31], a[224:227], a[132:135], v[16:31]
buffer_load_dwordx4 v180, s[4:7], 0 offen offset:0 sc1 lds
v_add_u32_dpp v181, v208, v205 row_newbcast:5 row_mask:0xf bank_mask:0xf
buffer_load_dwordx4 v181, s[4:7], 0 offen offset:1024 sc1 lds
v_add_u32_dpp v182, v208, v206 row_newbcast:6 row_mask:0xf bank_mask:0xf
s_waitcnt lgkmcnt(0)
v_mfma_f32_32x32x16_bf16 v[0:15], a[232:235], a[144:147], v[0:15]
buffer_load_dwordx4 v182, s[4:7], 0 offen offset:2048 sc1 lds
v_add_u32_dpp v183, v208, v207 row_newbcast:7 row_mask:0xf bank_mask:0xf
v_mfma_f32_32x32x16_bf16 v[16:31], a[232:235], a[148:151], v[16:31]
buffer_load_dwordx4 v183, s[4:7], 0 offen offset:3072 sc1 lds
K2_LOOP:
v_mfma_f32_32x32x16_bf16 v[32:47], a[176:179], a[248:251], 0
ds_read_b128 v[212:215], v228 offset:512
ds_read_b32 v219, v228 offset:1036
v_cvt_pk_bf16_f32 v160, v128, v129
v_cvt_pk_bf16_f32 v161, v130, v131
v_cvt_pk_bf16_f32 v162, v132, v133
v_cvt_pk_bf16_f32 v163, v134, v135
v_cvt_pk_bf16_f32 v164, v136, v137
v_mfma_f32_32x32x16_bf16 v[48:63], a[184:187], a[248:251], 0
s_cmp_lt_i32 s37, s44
ds_read_u16 v208, v229 offset:1544
v_cvt_pk_bf16_f32 v165, v138, v139
v_cvt_pk_bf16_f32 v166, v140, v141
v_cvt_pk_bf16_f32 v167, v142, v143
v_cvt_pk_bf16_f32 v168, v144, v145
v_cvt_pk_bf16_f32 v169, v146, v147
v_mfma_f32_32x32x16_bf16 v[32:47], a[180:183], a[252:255], v[32:47]
v_cvt_pk_bf16_f32 v170, v148, v149
v_cvt_pk_bf16_f32 v171, v150, v151
v_cvt_pk_bf16_f32 v172, v152, v153
v_cvt_pk_bf16_f32 v173, v154, v155
v_cvt_pk_bf16_f32 v174, v156, v157
v_cvt_pk_bf16_f32 v175, v158, v159
v_mfma_f32_32x32x16_bf16 v[48:63], a[188:191], a[252:255], v[48:63]
v_exp_f32 v128, v0
v_exp_f32 v129, v1
v_exp_f32 v130, v2
v_mfma_f32_32x32x16_bf16 v[96:111], a[236:239], v[160:163], v[96:111]
s_waitcnt vmcnt(9)
ds_read_b128 a[160:163], v192 offset:8192
ds_read_b128 a[164:167], v193 offset:8192
v_sub_f32 v248, v216, v220
v_sub_f32 v249, v217, v221
v_exp_f32 v131, v3
v_exp_f32 v132, v4
v_exp_f32 v133, v5
v_mfma_f32_32x32x16_bf16 v[112:127], a[236:239], v[168:171], v[112:127]
s_cselect_b32 s10, s55, 0
ds_read_b64_tr_b16 a[236:237], v230 offset:0
ds_read_b64_tr_b16 a[238:239], v230 offset:512
ds_read_b128 a[168:171], v194 offset:8192
v_sub_f32 v250, v218, v222
v_mul_f32 v251, v248, v248
v_exp_f32 v134, v6
v_exp_f32 v135, v7
v_exp_f32 v136, v8
v_exp_f32 v137, v9
v_mfma_f32_32x32x16_bf16 v[96:111], a[240:243], v[164:167], v[96:111]
s_add_u32 s37, s37, 1
ds_read_b128 a[172:175], v195 offset:8192
ds_read_b128 a[176:179], v196 offset:8192
v_cvt_pk_bf16_f32 v248, v248, v249
v_fmac_f32 v251, v249, v249
v_exp_f32 v138, v10
v_exp_f32 v139, v11
v_exp_f32 v140, v12
v_exp_f32 v141, v13
v_mfma_f32_32x32x16_bf16 v[112:127], a[240:243], v[172:175], v[112:127]
s_cmp_lt_i32 s37, s44
ds_read_b64_tr_b16 a[240:241], v230 offset:1024
ds_read_b64_tr_b16 a[242:243], v230 offset:1536
ds_read_b128 a[180:183], v197 offset:8192
v_cvt_pk_bf16_f32 v249, v250, 1.0
v_fmac_f32 v251, v250, v250
v_cmp_gt_u32 s[56:57], s67, v239
v_cmp_le_i16 vcc, 0, v241
v_exp_f32 v142, v14
v_exp_f32 v143, v15
v_exp_f32 v144, v16
v_exp_f32 v145, v17
v_mfma_f32_32x32x8bf16_1k v[128:143], a[64:65], a[64:65], v[128:143]
s_cselect_b32 s6, s54, 0
ds_read_b128 a[184:187], v198 offset:8192
ds_read_b128 a[188:191], v199 offset:8192
v_cvt_pk_bf16_f32 v251, v251, v251
v_exp_f32 v146, v18
v_exp_f32 v147, v19
v_exp_f32 v148, v20
v_exp_f32 v149, v21
v_exp_f32 v150, v22
v_mfma_f32_32x32x16_bf16 v[32:47], a[224:227], a[136:139], v[32:47]
s_and_b64 exec, s[56:57], vcc
ds_write_b64 v239, v[248:249] offset:1024
ds_write_b16 v239, v251 offset:1032
s_mov_b64 exec, -1
v_exp_f32 v151, v23
v_exp_f32 v152, v24
v_exp_f32 v153, v25
v_exp_f32 v154, v26
v_exp_f32 v155, v27
v_mfma_f32_32x32x16_bf16 v[48:63], a[224:227], a[140:143], v[48:63]
s_cmp_ge_i32 s37, s38
ds_read_b32 v241, v239 offset:2056
v_exp_f32 v156, v28
v_exp_f32 v157, v29
v_exp_f32 v158, v30
v_exp_f32 v159, v31
v_rcp_f32 v128, v128
v_rcp_f32 v129, v129
v_mfma_f32_32x32x8bf16_1k v[144:159], a[64:65], a[64:65], v[144:159]
v_rcp_f32 v130, v130
v_rcp_f32 v131, v131
v_rcp_f32 v132, v132
v_rcp_f32 v133, v133
v_rcp_f32 v134, v134
v_rcp_f32 v135, v135
v_rcp_f32 v136, v136
v_rcp_f32 v137, v137
v_mfma_f32_32x32x16_bf16 v[32:47], a[232:235], a[152:155], v[32:47]
v_rcp_f32 v138, v138
v_rcp_f32 v139, v139
v_rcp_f32 v140, v140
v_rcp_f32 v141, v141
v_rcp_f32 v142, v142
v_rcp_f32 v143, v143
v_rcp_f32 v144, v144
v_rcp_f32 v145, v145
v_mfma_f32_32x32x16_bf16 v[48:63], a[232:235], a[156:159], v[48:63]
v_rcp_f32 v146, v146
v_rcp_f32 v147, v147
v_rcp_f32 v148, v148
v_rcp_f32 v149, v149
v_rcp_f32 v150, v150
v_rcp_f32 v151, v151
v_rcp_f32 v152, v152
v_rcp_f32 v153, v153
v_rcp_f32 v154, v154
v_rcp_f32 v155, v155
v_rcp_f32 v156, v156
v_rcp_f32 v157, v157
v_rcp_f32 v158, v158
v_rcp_f32 v159, v159
v_pk_mul_f32 v[128:129], v[0:1], v[128:129]
v_pk_mul_f32 v[130:131], v[2:3], v[130:131]
v_pk_mul_f32 v[132:133], v[4:5], v[132:133]
v_pk_mul_f32 v[134:135], v[6:7], v[134:135]
v_pk_mul_f32 v[136:137], v[8:9], v[136:137]
v_pk_mul_f32 v[138:139], v[10:11], v[138:139]
v_pk_mul_f32 v[140:141], v[12:13], v[140:141]
v_pk_mul_f32 v[142:143], v[14:15], v[142:143]
v_pk_mul_f32 v[144:145], v[16:17], v[144:145]
v_pk_mul_f32 v[146:147], v[18:19], v[146:147]
v_pk_mul_f32 v[148:149], v[20:21], v[148:149]
v_pk_mul_f32 v[150:151], v[22:23], v[150:151]
v_pk_mul_f32 v[152:153], v[24:25], v[152:153]
v_pk_mul_f32 v[154:155], v[26:27], v[154:155]
v_pk_mul_f32 v[156:157], v[28:29], v[156:157]
v_pk_mul_f32 v[158:159], v[30:31], v[158:159]
K2_AE:
s_waitcnt lgkmcnt(0)
s_cbranch_scc1 K2_H
K2_B0:
v_mfma_f32_32x32x16_bf16 v[0:15], a[160:163], a[248:251], 0
ds_write_b64 v232, a[244:245]
v_mad_u32_u16 v234, v214, v235, v236 op_sel:[1,0,0,0]
v_dot2_u32_u16 v255, v219, s50, v238
v_mad_u32_u16 v233, v214, 1, v231 op_sel:[1,0,0,0]
v_cvt_pk_bf16_f32 v160, v128, v129
v_cvt_pk_bf16_f32 v161, v130, v131
v_cvt_pk_bf16_f32 v162, v132, v133
v_cvt_pk_bf16_f32 v163, v134, v135
v_mfma_f32_32x32x16_bf16 v[16:31], a[168:171], a[248:251], 0
s_mov_b32 m0, s48
ds_read_b128 a[232:235], v234
ds_write_b64 v233, v[212:213]
buffer_load_dwordx4 a[224:227], v255, s[8:11], 0 offen
v_cvt_pk_bf16_f32 v164, v136, v137
v_cvt_pk_bf16_f32 v165, v138, v139
v_mfma_f32_32x32x16_bf16 v[0:15], a[164:167], a[252:255], v[0:15]
v_lshlrev_b32 v208, 8, v208
v_cvt_pk_bf16_f32 v166, v140, v141
v_cvt_pk_bf16_f32 v167, v142, v143
v_cvt_pk_bf16_f32 v168, v144, v145
v_cvt_pk_bf16_f32 v169, v146, v147
v_cvt_pk_bf16_f32 v170, v148, v149
v_mfma_f32_32x32x16_bf16 v[16:31], a[172:175], a[252:255], v[16:31]
v_cvt_pk_bf16_f32 v171, v150, v151
v_cvt_pk_bf16_f32 v172, v152, v153
v_cvt_pk_bf16_f32 v173, v154, v155
v_cvt_pk_bf16_f32 v174, v156, v157
v_cvt_pk_bf16_f32 v175, v158, v159
v_exp_f32 v128, v32
v_exp_f32 v129, v33
v_mfma_f32_32x32x16_bf16 v[64:79], a[236:239], v[160:163], v[64:79]
s_waitcnt vmcnt(9)
v_add_u32_dpp v176, v208, v200 row_newbcast:0 row_mask:0xf bank_mask:0xf
v_exp_f32 v130, v34
v_exp_f32 v131, v35
v_exp_f32 v132, v36
v_exp_f32 v133, v37
v_mfma_f32_32x32x16_bf16 v[80:95], a[236:239], v[168:171], v[80:95]
buffer_load_dwordx4 v176, s[4:7], 0 offen offset:0 sc1 lds
v_add_u32_dpp v177, v208, v201 row_newbcast:1 row_mask:0xf bank_mask:0xf
v_add_u32 v236, v237, v236
v_exp_f32 v134, v38
v_exp_f32 v135, v39
v_exp_f32 v136, v40
v_exp_f32 v137, v41
v_mfma_f32_32x32x16_bf16 v[64:79], a[240:243], v[164:167], v[64:79]
buffer_load_dwordx4 v177, s[4:7], 0 offen offset:1024 sc1 lds
v_add_u32_dpp v178, v208, v202 row_newbcast:2 row_mask:0xf bank_mask:0xf
v_exp_f32 v138, v42
v_exp_f32 v139, v43
v_exp_f32 v140, v44
v_exp_f32 v141, v45
v_mfma_f32_32x32x16_bf16 v[80:95], a[240:243], v[172:175], v[80:95]
buffer_load_dwordx4 v178, s[4:7], 0 offen offset:2048 sc1 lds
v_add_u32_dpp v179, v208, v203 row_newbcast:3 row_mask:0xf bank_mask:0xf
v_exp_f32 v142, v46
v_exp_f32 v143, v47
v_exp_f32 v144, v48
v_exp_f32 v145, v49
v_mfma_f32_32x32x8bf16_1k v[128:143], a[64:65], a[64:65], v[128:143]
buffer_load_dwordx4 v179, s[4:7], 0 offen offset:3072 sc1 lds
v_exp_f32 v146, v50
v_exp_f32 v147, v51
v_exp_f32 v148, v52
v_exp_f32 v149, v53
v_exp_f32 v150, v54
v_mfma_f32_32x32x16_bf16 v[0:15], a[228:231], a[128:131], v[0:15]
s_mov_b32 m0, s49
v_add_u32_dpp v180, v208, v204 row_newbcast:4 row_mask:0xf bank_mask:0xf
v_exp_f32 v151, v55
v_exp_f32 v152, v56
v_exp_f32 v153, v57
v_exp_f32 v154, v58
v_exp_f32 v155, v59
v_mfma_f32_32x32x16_bf16 v[16:31], a[228:231], a[132:135], v[16:31]
buffer_load_dwordx4 v180, s[4:7], 0 offen offset:0 sc1 lds
v_add_u32_dpp v181, v208, v205 row_newbcast:5 row_mask:0xf bank_mask:0xf
v_exp_f32 v156, v60
v_exp_f32 v157, v61
v_exp_f32 v158, v62
v_exp_f32 v159, v63
v_rcp_f32 v128, v128
v_rcp_f32 v129, v129
v_mfma_f32_32x32x8bf16_1k v[144:159], a[64:65], a[64:65], v[144:159]
buffer_load_dwordx4 v181, s[4:7], 0 offen offset:1024 sc1 lds
v_add_u32_dpp v182, v208, v206 row_newbcast:6 row_mask:0xf bank_mask:0xf
v_rcp_f32 v130, v130
v_rcp_f32 v131, v131
v_rcp_f32 v132, v132
v_rcp_f32 v133, v133
v_rcp_f32 v134, v134
v_rcp_f32 v135, v135
v_rcp_f32 v136, v136
v_rcp_f32 v137, v137
s_waitcnt lgkmcnt(0)
v_mfma_f32_32x32x16_bf16 v[0:15], a[232:235], a[144:147], v[0:15]
buffer_load_dwordx4 v182, s[4:7], 0 offen offset:2048 sc1 lds
v_add_u32_dpp v183, v208, v207 row_newbcast:7 row_mask:0xf bank_mask:0xf
v_rcp_f32 v138, v138
v_rcp_f32 v139, v139
v_rcp_f32 v140, v140
v_rcp_f32 v141, v141
v_rcp_f32 v142, v142
v_rcp_f32 v143, v143
v_rcp_f32 v144, v144
v_rcp_f32 v145, v145
v_mfma_f32_32x32x16_bf16 v[16:31], a[232:235], a[148:151], v[16:31]
buffer_load_dwordx4 v183, s[4:7], 0 offen offset:3072 sc1 lds
v_rcp_f32 v146, v146
v_rcp_f32 v147, v147
v_rcp_f32 v148, v148
v_rcp_f32 v149, v149
v_rcp_f32 v150, v150
v_rcp_f32 v151, v151
v_rcp_f32 v152, v152
v_rcp_f32 v153, v153
v_rcp_f32 v154, v154
v_rcp_f32 v155, v155
v_rcp_f32 v156, v156
v_rcp_f32 v157, v157
v_rcp_f32 v158, v158
v_rcp_f32 v159, v159
v_pk_mul_f32 v[128:129], v[32:33], v[128:129]
v_pk_mul_f32 v[130:131], v[34:35], v[130:131]
v_pk_mul_f32 v[132:133], v[36:37], v[132:133]
v_pk_mul_f32 v[134:135], v[38:39], v[134:135]
v_pk_mul_f32 v[136:137], v[40:41], v[136:137]
v_pk_mul_f32 v[138:139], v[42:43], v[138:139]
v_pk_mul_f32 v[140:141], v[44:45], v[140:141]
v_pk_mul_f32 v[142:143], v[46:47], v[142:143]
v_pk_mul_f32 v[144:145], v[48:49], v[144:145]
v_pk_mul_f32 v[146:147], v[50:51], v[146:147]
v_pk_mul_f32 v[148:149], v[52:53], v[148:149]
v_pk_mul_f32 v[150:151], v[54:55], v[150:151]
v_pk_mul_f32 v[152:153], v[56:57], v[152:153]
v_pk_mul_f32 v[154:155], v[58:59], v[154:155]
v_pk_mul_f32 v[156:157], v[60:61], v[156:157]
v_pk_mul_f32 v[158:159], v[62:63], v[158:159]
v_mfma_f32_32x32x16_bf16 v[32:47], a[176:179], a[248:251], 0
s_cmp_lt_i32 s37, s44
ds_read_b128 v[212:215], v228 offset:1024
ds_read_b32 v219, v228 offset:1548
v_cvt_pk_bf16_f32 v160, v128, v129
v_cvt_pk_bf16_f32 v161, v130, v131
v_cvt_pk_bf16_f32 v162, v132, v133
v_cvt_pk_bf16_f32 v163, v134, v135
v_mfma_f32_32x32x16_bf16 v[48:63], a[184:187], a[248:251], 0
s_cselect_b32 s10, s55, 0
ds_read_u16 v208, v229 offset:2056
v_mad_u32_u16 v248, v241, 6, 0
v_mad_u32_u16 v249, v241, 2, 0 op_sel:[1,0,0,0]
v_cvt_pk_bf16_f32 v164, v136, v137
v_cvt_pk_bf16_f32 v165, v138, v139
v_cvt_pk_bf16_f32 v166, v140, v141
v_cvt_pk_bf16_f32 v167, v142, v143
v_cvt_pk_bf16_f32 v168, v144, v145
v_mfma_f32_32x32x16_bf16 v[32:47], a[180:183], a[252:255], v[32:47]
s_add_u32 s37, s37, 1
ds_read_b96 v[216:218], v249 offset:0
buffer_load_short_d16_hi v220, v248, s[12:15], 0 offen offset:0
v_cvt_pk_bf16_f32 v169, v146, v147
v_cvt_pk_bf16_f32 v170, v148, v149
v_cvt_pk_bf16_f32 v171, v150, v151
v_cvt_pk_bf16_f32 v172, v152, v153
v_cvt_pk_bf16_f32 v173, v154, v155
v_mfma_f32_32x32x16_bf16 v[48:63], a[188:191], a[252:255], v[48:63]
buffer_load_short_d16_hi v221, v248, s[12:15], 0 offen offset:2
v_cvt_pk_bf16_f32 v174, v156, v157
v_cvt_pk_bf16_f32 v175, v158, v159
v_exp_f32 v128, v0
v_exp_f32 v129, v1
v_mfma_f32_32x32x16_bf16 v[96:111], a[236:239], v[160:163], v[96:111]
s_waitcnt vmcnt(11)
ds_read_b128 a[160:163], v192 offset:0
ds_read_b128 a[164:167], v193 offset:0
buffer_load_short_d16_hi v222, v248, s[12:15], 0 offen offset:4
v_exp_f32 v130, v2
v_exp_f32 v131, v3
v_exp_f32 v132, v4
v_exp_f32 v133, v5
v_mfma_f32_32x32x16_bf16 v[112:127], a[236:239], v[168:171], v[112:127]
s_cmp_lt_i32 s37, s44
ds_read_b64_tr_b16 a[236:237], v230 offset:0
ds_read_b64_tr_b16 a[238:239], v230 offset:512
ds_read_b128 a[168:171], v194 offset:0
v_exp_f32 v134, v6
v_exp_f32 v135, v7
v_exp_f32 v136, v8
v_exp_f32 v137, v9
v_mfma_f32_32x32x16_bf16 v[96:111], a[240:243], v[164:167], v[96:111]
s_cselect_b32 s6, s54, 0
ds_read_b128 a[172:175], v195 offset:0
ds_read_b128 a[176:179], v196 offset:0
v_exp_f32 v138, v10
v_exp_f32 v139, v11
v_exp_f32 v140, v12
v_exp_f32 v141, v13
v_mfma_f32_32x32x16_bf16 v[112:127], a[240:243], v[172:175], v[112:127]
s_cmp_ge_i32 s37, s38
ds_read_b64_tr_b16 a[240:241], v230 offset:1024
ds_read_b64_tr_b16 a[242:243], v230 offset:1536
ds_read_b128 a[180:183], v197 offset:0
v_exp_f32 v142, v14
v_exp_f32 v143, v15
v_exp_f32 v144, v16
v_exp_f32 v145, v17
v_mfma_f32_32x32x8bf16_1k v[128:143], a[64:65], a[64:65], v[128:143]
ds_read_b128 a[184:187], v198 offset:0
ds_read_b128 a[188:191], v199 offset:0
v_exp_f32 v146, v18
v_exp_f32 v147, v19
v_exp_f32 v148, v20
v_exp_f32 v149, v21
v_exp_f32 v150, v22
v_mfma_f32_32x32x16_bf16 v[32:47], a[228:231], a[136:139], v[32:47]
v_add_u32 v228, 1024, v228
v_add_u32 v229, 1024, v229
v_exp_f32 v151, v23
v_exp_f32 v152, v24
v_exp_f32 v153, v25
v_exp_f32 v154, v26
v_exp_f32 v155, v27
v_mfma_f32_32x32x16_bf16 v[48:63], a[228:231], a[140:143], v[48:63]
v_add_u32 v239, 1024, v239
v_exp_f32 v156, v28
v_exp_f32 v157, v29
v_exp_f32 v158, v30
v_exp_f32 v159, v31
v_rcp_f32 v128, v128
v_rcp_f32 v129, v129
v_mfma_f32_32x32x8bf16_1k v[144:159], a[64:65], a[64:65], v[144:159]
v_rcp_f32 v130, v130
v_rcp_f32 v131, v131
v_rcp_f32 v132, v132
v_rcp_f32 v133, v133
v_rcp_f32 v134, v134
v_rcp_f32 v135, v135
v_rcp_f32 v136, v136
v_rcp_f32 v137, v137
v_mfma_f32_32x32x16_bf16 v[32:47], a[232:235], a[152:155], v[32:47]
v_rcp_f32 v138, v138
v_rcp_f32 v139, v139
v_rcp_f32 v140, v140
v_rcp_f32 v141, v141
v_rcp_f32 v142, v142
v_rcp_f32 v143, v143
v_rcp_f32 v144, v144
v_rcp_f32 v145, v145
v_mfma_f32_32x32x16_bf16 v[48:63], a[232:235], a[156:159], v[48:63]
v_rcp_f32 v146, v146
v_rcp_f32 v147, v147
v_rcp_f32 v148, v148
v_rcp_f32 v149, v149
v_rcp_f32 v150, v150
v_rcp_f32 v151, v151
v_rcp_f32 v152, v152
v_rcp_f32 v153, v153
v_rcp_f32 v154, v154
v_rcp_f32 v155, v155
v_rcp_f32 v156, v156
v_rcp_f32 v157, v157
v_rcp_f32 v158, v158
v_rcp_f32 v159, v159
v_pk_mul_f32 v[128:129], v[0:1], v[128:129]
v_pk_mul_f32 v[130:131], v[2:3], v[130:131]
v_pk_mul_f32 v[132:133], v[4:5], v[132:133]
v_pk_mul_f32 v[134:135], v[6:7], v[134:135]
v_pk_mul_f32 v[136:137], v[8:9], v[136:137]
v_pk_mul_f32 v[138:139], v[10:11], v[138:139]
v_pk_mul_f32 v[140:141], v[12:13], v[140:141]
v_pk_mul_f32 v[142:143], v[14:15], v[142:143]
v_pk_mul_f32 v[144:145], v[16:17], v[144:145]
v_pk_mul_f32 v[146:147], v[18:19], v[146:147]
v_pk_mul_f32 v[148:149], v[20:21], v[148:149]
v_pk_mul_f32 v[150:151], v[22:23], v[150:151]
v_pk_mul_f32 v[152:153], v[24:25], v[152:153]
v_pk_mul_f32 v[154:155], v[26:27], v[154:155]
v_pk_mul_f32 v[156:157], v[28:29], v[156:157]
v_pk_mul_f32 v[158:159], v[30:31], v[158:159]
s_waitcnt lgkmcnt(0)
s_cbranch_scc1 K2_H
K2_B1:
v_mfma_f32_32x32x16_bf16 v[0:15], a[160:163], a[248:251], 0
ds_write_b64 v233, a[244:245]
v_mad_u32_u16 v234, v214, v235, v236 op_sel:[1,0,0,0]
v_dot2_u32_u16 v255, v219, s50, v238
v_mad_u32_u16 v232, v214, 1, v231 op_sel:[1,0,0,0]
v_cvt_pk_bf16_f32 v160, v128, v129
v_cvt_pk_bf16_f32 v161, v130, v131
v_cvt_pk_bf16_f32 v162, v132, v133
v_cvt_pk_bf16_f32 v163, v134, v135
v_mfma_f32_32x32x16_bf16 v[16:31], a[168:171], a[248:251], 0
s_mov_b32 m0, s46
ds_read_b128 a[232:235], v234
ds_write_b64 v232, v[212:213]
buffer_load_dwordx4 a[228:231], v255, s[8:11], 0 offen
v_cvt_pk_bf16_f32 v164, v136, v137
v_cvt_pk_bf16_f32 v165, v138, v139
v_mfma_f32_32x32x16_bf16 v[0:15], a[164:167], a[252:255], v[0:15]
v_lshlrev_b32 v208, 8, v208
v_cvt_pk_bf16_f32 v166, v140, v141
v_cvt_pk_bf16_f32 v167, v142, v143
v_cvt_pk_bf16_f32 v168, v144, v145
v_cvt_pk_bf16_f32 v169, v146, v147
v_cvt_pk_bf16_f32 v170, v148, v149
v_mfma_f32_32x32x16_bf16 v[16:31], a[172:175], a[252:255], v[16:31]
v_cvt_pk_bf16_f32 v171, v150, v151
v_cvt_pk_bf16_f32 v172, v152, v153
v_cvt_pk_bf16_f32 v173, v154, v155
v_cvt_pk_bf16_f32 v174, v156, v157
v_cvt_pk_bf16_f32 v175, v158, v159
v_exp_f32 v128, v32
v_exp_f32 v129, v33
v_mfma_f32_32x32x16_bf16 v[64:79], a[236:239], v[160:163], v[64:79]
s_waitcnt vmcnt(12)
v_add_u32_dpp v176, v208, v200 row_newbcast:0 row_mask:0xf bank_mask:0xf
v_exp_f32 v130, v34
v_exp_f32 v131, v35
v_exp_f32 v132, v36
v_exp_f32 v133, v37
v_mfma_f32_32x32x16_bf16 v[80:95], a[236:239], v[168:171], v[80:95]
buffer_load_dwordx4 v176, s[4:7], 0 offen offset:0 sc1 lds
v_add_u32_dpp v177, v208, v201 row_newbcast:1 row_mask:0xf bank_mask:0xf
v_add_u32 v236, v237, v236
v_exp_f32 v134, v38
v_exp_f32 v135, v39
v_exp_f32 v136, v40
v_exp_f32 v137, v41
v_mfma_f32_32x32x16_bf16 v[64:79], a[240:243], v[164:167], v[64:79]
buffer_load_dwordx4 v177, s[4:7], 0 offen offset:1024 sc1 lds
v_add_u32_dpp v178, v208, v202 row_newbcast:2 row_mask:0xf bank_mask:0xf
v_exp_f32 v138, v42
v_exp_f32 v139, v43
v_exp_f32 v140, v44
v_exp_f32 v141, v45
v_mfma_f32_32x32x16_bf16 v[80:95], a[240:243], v[172:175], v[80:95]
buffer_load_dwordx4 v178, s[4:7], 0 offen offset:2048 sc1 lds
v_add_u32_dpp v179, v208, v203 row_newbcast:3 row_mask:0xf bank_mask:0xf
v_exp_f32 v142, v46
v_exp_f32 v143, v47
v_exp_f32 v144, v48
v_exp_f32 v145, v49
v_mfma_f32_32x32x8bf16_1k v[128:143], a[64:65], a[64:65], v[128:143]
buffer_load_dwordx4 v179, s[4:7], 0 offen offset:3072 sc1 lds
v_exp_f32 v146, v50
v_exp_f32 v147, v51
v_exp_f32 v148, v52
v_exp_f32 v149, v53
v_exp_f32 v150, v54
v_mfma_f32_32x32x16_bf16 v[0:15], a[224:227], a[128:131], v[0:15]
s_mov_b32 m0, s47
v_add_u32_dpp v180, v208, v204 row_newbcast:4 row_mask:0xf bank_mask:0xf
v_exp_f32 v151, v55
v_exp_f32 v152, v56
v_exp_f32 v153, v57
v_exp_f32 v154, v58
v_exp_f32 v155, v59
v_mfma_f32_32x32x16_bf16 v[16:31], a[224:227], a[132:135], v[16:31]
buffer_load_dwordx4 v180, s[4:7], 0 offen offset:0 sc1 lds
v_add_u32_dpp v181, v208, v205 row_newbcast:5 row_mask:0xf bank_mask:0xf
v_exp_f32 v156, v60
v_exp_f32 v157, v61
v_exp_f32 v158, v62
v_exp_f32 v159, v63
v_rcp_f32 v128, v128
v_rcp_f32 v129, v129
v_mfma_f32_32x32x8bf16_1k v[144:159], a[64:65], a[64:65], v[144:159]
buffer_load_dwordx4 v181, s[4:7], 0 offen offset:1024 sc1 lds
v_add_u32_dpp v182, v208, v206 row_newbcast:6 row_mask:0xf bank_mask:0xf
v_rcp_f32 v130, v130
v_rcp_f32 v131, v131
v_rcp_f32 v132, v132
v_rcp_f32 v133, v133
v_rcp_f32 v134, v134
v_rcp_f32 v135, v135
v_rcp_f32 v136, v136
v_rcp_f32 v137, v137
s_waitcnt lgkmcnt(0)
v_mfma_f32_32x32x16_bf16 v[0:15], a[232:235], a[144:147], v[0:15]
buffer_load_dwordx4 v182, s[4:7], 0 offen offset:2048 sc1 lds
v_add_u32_dpp v183, v208, v207 row_newbcast:7 row_mask:0xf bank_mask:0xf
v_rcp_f32 v138, v138
v_rcp_f32 v139, v139
v_rcp_f32 v140, v140
v_rcp_f32 v141, v141
v_rcp_f32 v142, v142
v_rcp_f32 v143, v143
v_rcp_f32 v144, v144
v_rcp_f32 v145, v145
v_mfma_f32_32x32x16_bf16 v[16:31], a[232:235], a[148:151], v[16:31]
buffer_load_dwordx4 v183, s[4:7], 0 offen offset:3072 sc1 lds
v_rcp_f32 v146, v146
v_rcp_f32 v147, v147
v_rcp_f32 v148, v148
v_rcp_f32 v149, v149
v_rcp_f32 v150, v150
v_rcp_f32 v151, v151
v_rcp_f32 v152, v152
v_rcp_f32 v153, v153
v_rcp_f32 v154, v154
v_rcp_f32 v155, v155
v_rcp_f32 v156, v156
v_rcp_f32 v157, v157
v_rcp_f32 v158, v158
v_rcp_f32 v159, v159
v_pk_mul_f32 v[128:129], v[32:33], v[128:129]
v_pk_mul_f32 v[130:131], v[34:35], v[130:131]
v_pk_mul_f32 v[132:133], v[36:37], v[132:133]
v_pk_mul_f32 v[134:135], v[38:39], v[134:135]
v_pk_mul_f32 v[136:137], v[40:41], v[136:137]
v_pk_mul_f32 v[138:139], v[42:43], v[138:139]
v_pk_mul_f32 v[140:141], v[44:45], v[140:141]
v_pk_mul_f32 v[142:143], v[46:47], v[142:143]
v_pk_mul_f32 v[144:145], v[48:49], v[144:145]
v_pk_mul_f32 v[146:147], v[50:51], v[146:147]
v_pk_mul_f32 v[148:149], v[52:53], v[148:149]
v_pk_mul_f32 v[150:151], v[54:55], v[150:151]
v_pk_mul_f32 v[152:153], v[56:57], v[152:153]
v_pk_mul_f32 v[154:155], v[58:59], v[154:155]
v_pk_mul_f32 v[156:157], v[60:61], v[156:157]
v_pk_mul_f32 v[158:159], v[62:63], v[158:159]
s_branch K2_LOOP
K2_H:
s_cmp_lg_u32 s37, s39
s_cbranch_scc1 K2_NOFL
s_mul_i32 s56, s42, 34
v_add_u32 v234, s56, v245
v_add_u32 v255, s56, v246
s_cmp_lg_u32 s31, 0
s_cbranch_scc1 K2_HF
ds_read_b32 v0, v234
ds_read_b32 v1, v234 offset:128
ds_read_b32 v10, v255
v_mov_b32 v9, s45
v_pk_mul_f32 v[176:177], v[64:65], v[224:225] op_sel:[0,0] op_sel_hi:[1,0]
v_pk_mul_f32 v[178:179], v[66:67], v[224:225] op_sel:[0,0] op_sel_hi:[1,0]
v_pk_mul_f32 v[180:181], v[68:69], v[224:225] op_sel:[0,0] op_sel_hi:[1,0]
v_pk_mul_f32 v[182:183], v[70:71], v[224:225] op_sel:[0,0] op_sel_hi:[1,0]
v_pk_mul_f32 v[184:185], v[72:73], v[224:225] op_sel:[0,0] op_sel_hi:[1,0]
v_pk_mul_f32 v[186:187], v[74:75], v[224:225] op_sel:[0,0] op_sel_hi:[1,0]
v_pk_mul_f32 v[188:189], v[76:77], v[224:225] op_sel:[0,0] op_sel_hi:[1,0]
v_pk_mul_f32 v[190:191], v[78:79], v[224:225] op_sel:[0,0] op_sel_hi:[1,0]
v_pk_fma_f32 v[176:177], v[80:81], v[224:225], v[176:177] op_sel:[0,1,0] op_sel_hi:[1,1,1]
v_pk_fma_f32 v[178:179], v[82:83], v[224:225], v[178:179] op_sel:[0,1,0] op_sel_hi:[1,1,1]
v_pk_fma_f32 v[180:181], v[84:85], v[224:225], v[180:181] op_sel:[0,1,0] op_sel_hi:[1,1,1]
v_pk_fma_f32 v[182:183], v[86:87], v[224:225], v[182:183] op_sel:[0,1,0] op_sel_hi:[1,1,1]
v_pk_fma_f32 v[184:185], v[88:89], v[224:225], v[184:185] op_sel:[0,1,0] op_sel_hi:[1,1,1]
v_pk_fma_f32 v[186:187], v[90:91], v[224:225], v[186:187] op_sel:[0,1,0] op_sel_hi:[1,1,1]
v_pk_fma_f32 v[188:189], v[92:93], v[224:225], v[188:189] op_sel:[0,1,0] op_sel_hi:[1,1,1]
v_pk_fma_f32 v[190:191], v[94:95], v[224:225], v[190:191] op_sel:[0,1,0] op_sel_hi:[1,1,1]
v_pk_fma_f32 v[176:177], v[96:97], v[226:227], v[176:177] op_sel:[0,0,0] op_sel_hi:[1,0,1]
v_pk_fma_f32 v[178:179], v[98:99], v[226:227], v[178:179] op_sel:[0,0,0] op_sel_hi:[1,0,1]
v_pk_fma_f32 v[180:181], v[100:101], v[226:227], v[180:181] op_sel:[0,0,0] op_sel_hi:[1,0,1]
v_pk_fma_f32 v[182:183], v[102:103], v[226:227], v[182:183] op_sel:[0,0,0] op_sel_hi:[1,0,1]
v_pk_fma_f32 v[184:185], v[104:105], v[226:227], v[184:185] op_sel:[0,0,0] op_sel_hi:[1,0,1]
v_pk_fma_f32 v[186:187], v[106:107], v[226:227], v[186:187] op_sel:[0,0,0] op_sel_hi:[1,0,1]
v_pk_fma_f32 v[188:189], v[108:109], v[226:227], v[188:189] op_sel:[0,0,0] op_sel_hi:[1,0,1]
v_pk_fma_f32 v[190:191], v[110:111], v[226:227], v[190:191] op_sel:[0,0,0] op_sel_hi:[1,0,1]
v_pk_fma_f32 v[176:177], v[112:113], v[226:227], v[176:177] op_sel:[0,1,0] op_sel_hi:[1,1,1]
v_pk_fma_f32 v[178:179], v[114:115], v[226:227], v[178:179] op_sel:[0,1,0] op_sel_hi:[1,1,1]
v_pk_fma_f32 v[180:181], v[116:117], v[226:227], v[180:181] op_sel:[0,1,0] op_sel_hi:[1,1,1]
v_pk_fma_f32 v[182:183], v[118:119], v[226:227], v[182:183] op_sel:[0,1,0] op_sel_hi:[1,1,1]
v_pk_fma_f32 v[184:185], v[120:121], v[226:227], v[184:185] op_sel:[0,1,0] op_sel_hi:[1,1,1]
v_pk_fma_f32 v[186:187], v[122:123], v[226:227], v[186:187] op_sel:[0,1,0] op_sel_hi:[1,1,1]
v_pk_fma_f32 v[188:189], v[124:125], v[226:227], v[188:189] op_sel:[0,1,0] op_sel_hi:[1,1,1]
v_pk_fma_f32 v[190:191], v[126:127], v[226:227], v[190:191] op_sel:[0,1,0] op_sel_hi:[1,1,1]
v_cvt_pk_bf16_f32 v160, v176, v177
v_cvt_pk_bf16_f32 v161, v178, v179
v_cvt_pk_bf16_f32 v162, v180, v181
v_cvt_pk_bf16_f32 v163, v182, v183
v_cvt_pk_bf16_f32 v164, v184, v185
v_cvt_pk_bf16_f32 v165, v186, v187
v_cvt_pk_bf16_f32 v166, v188, v189
v_cvt_pk_bf16_f32 v167, v190, v191
v_cvt_pk_bf16_f32 v169, v71, v87
v_cvt_pk_bf16_f32 v170, v75, v91
v_mfma_f32_32x32x16_bf16 v[176:191], v[160:163], a[248:251], 0
s_waitcnt lgkmcnt(0)
ds_write_b32 v234, v169 offset:544
v_cvt_pk_bf16_f32 v171, v79, v95
v_cvt_pk_bf16_f32 v173, v103, v119
v_cvt_pk_bf16_f32 v174, v107, v123
v_cvt_pk_bf16_f32 v175, v111, v127
v_lshlrev_b32 v2, 16, v0
v_and_b32 v3, 0xffff0000, v0
v_mfma_f32_32x32x16_bf16 v[176:191], v[164:167], a[252:255], v[176:191]
ds_write_b32 v234, v170 offset:1088
ds_write_b32 v234, v171 offset:1632
v_add_f32 v2, v2, v67
v_add_f32 v3, v3, v83
v_cvt_pk_bf16_f32 v168, v2, v3
v_lshlrev_b32 v4, 16, v1
v_and_b32 v5, 0xffff0000, v1
v_add_f32 v4, v4, v99
v_add_f32 v5, v5, v115
v_cvt_pk_bf16_f32 v172, v4, v5
v_mfma_f32_32x32x16_bf16 v[64:79], a[244:247], a[244:247], 0
ds_write_b32 v234, v168 offset:0
ds_write_b32 v234, v173 offset:672
v_mfma_f32_32x32x16_bf16 v[80:95], a[244:247], a[244:247], 0
ds_write_b32 v234, v174 offset:1216
ds_write_b32 v234, v175 offset:1760
ds_write_b32 v234, v172 offset:128
v_add_f32 v176, v176, v184
v_add_f32 v177, v177, v185
v_mfma_f32_32x32x16_bf16 v[96:111], a[244:247], a[244:247], 0
v_add_f32 v178, v178, v186
v_add_f32 v179, v179, v187
v_add_f32 v180, v180, v188
v_add_f32 v181, v181, v189
v_add_f32 v182, v182, v190
v_add_f32 v183, v183, v191
v_mfma_f32_32x32x16_bf16 v[112:127], a[244:247], a[244:247], 0
v_add_f32 v176, v176, v180
v_add_f32 v177, v177, v181
v_add_f32 v178, v178, v182
v_add_f32 v179, v179, v183
v_add_f32 v176, v176, v178
v_add_f32 v177, v177, v179
v_add_f32 v176, v176, v177
v_mov_b32 v11, v176
s_nop 1
v_permlane32_swap_b32 v11, v176
v_add_f32 v10, v10, v11
v_add_f32 v10, v10, v176
ds_write_b32 v255, v10
ds_write_b32 v223, v9
K2_NOFL:
s_cmp_eq_u32 s37, s43
s_cbranch_scc1 K2_TAIL
s_mov_b32 s38, s40
s_cmp_lg_u32 s37, s40
s_cbranch_scc1 K2_RET
s_add_u32 s39, s37, 1
s_mul_i32 s58, s68, 33
s_mov_b32 s42, s41
s_lshr_b32 s58, s58, 1
s_mov_b32 s38, s39
s_add_u32 s57, s68, 56
v_mad_u32_u24 v234, v235, s58, v243
v_mad_u32_u24 v255, v235, s58, v244
s_sub_i32 s59, s41, s68
s_mov_b32 s41, s68
ds_read_b64_tr_b16 a[144:145], v234 offset:0
ds_read_b64_tr_b16 a[146:147], v255 offset:0
ds_read_b64_tr_b16 a[148:149], v234 offset:64
ds_read_b64_tr_b16 a[150:151], v255 offset:64
ds_read_b64_tr_b16 a[152:153], v234 offset:128
ds_read_b64_tr_b16 a[154:155], v255 offset:128
ds_read_b64_tr_b16 a[156:157], v234 offset:192
ds_read_b64_tr_b16 a[158:159], v255 offset:192
v_cmp_lt_u32 vcc, s57, v247
v_mad_i32_i24 v236, v235, s59, v236
v_add_u32 v231, s59, v231
s_ff1_i32_b32 s56, vcc_hi
s_sub_u32 s40, s56, 1
s_bitcmp1_b32 s37, 0
v_readlane_b32 s68, v247, s56
s_cbranch_scc1 K2_B1
s_branch K2_B0
K2_RET:
s_bitcmp1_b32 s37, 0
s_cbranch_scc1 K2_B1
s_branch K2_B0
K2_TAIL:
v_and_b32 v248, 63, v254
v_lshrrev_b32 v249, 4, v248
s_and_b32 s57, s30, 1
v_and_b32 v250, 1, v249
s_lshl_b32 s57, s57, 3
v_lshl_or_b32 v250, v250, 2, s57
v_and_b32 v248, 15, v248
v_xor_b32 v248, v248, v250
v_lshlrev_b32 v248, 4, v248
s_lshl_b32 s56, s30, 13
s_mov_b32 m0, s46
s_add_u32 s56, s56, 32768
s_mov_b32 s26, 65536
v_lshl_or_b32 v248, v249, 8, v248
buffer_load_dwordx4 v248, s[24:27], s56 offen offset:0 lds
buffer_load_dwordx4 v248, s[24:27], s56 offen offset:1024 lds
buffer_load_dwordx4 v248, s[24:27], s56 offen offset:2048 lds
buffer_load_dwordx4 v248, s[24:27], s56 offen offset:3072 lds
s_mov_b32 m0, s47
s_add_u32 s56, s56, 4096
buffer_load_dwordx4 v248, s[24:27], s56 offen offset:0 lds
buffer_load_dwordx4 v248, s[24:27], s56 offen offset:1024 lds
buffer_load_dwordx4 v248, s[24:27], s56 offen offset:2048 lds
buffer_load_dwordx4 v248, s[24:27], s56 offen offset:3072 lds
v_cvt_pk_bf16_f32 v160, v128, v129
v_cvt_pk_bf16_f32 v161, v130, v131
v_cvt_pk_bf16_f32 v162, v132, v133
v_cvt_pk_bf16_f32 v163, v134, v135
v_cvt_pk_bf16_f32 v164, v136, v137
v_cvt_pk_bf16_f32 v165, v138, v139
v_cvt_pk_bf16_f32 v166, v140, v141
v_cvt_pk_bf16_f32 v167, v142, v143
v_cvt_pk_bf16_f32 v168, v144, v145
v_cvt_pk_bf16_f32 v169, v146, v147
v_cvt_pk_bf16_f32 v170, v148, v149
v_cvt_pk_bf16_f32 v171, v150, v151
v_cvt_pk_bf16_f32 v172, v152, v153
v_cvt_pk_bf16_f32 v173, v154, v155
v_cvt_pk_bf16_f32 v174, v156, v157
v_cvt_pk_bf16_f32 v175, v158, v159
v_exp_f32 v128, v32
v_exp_f32 v129, v33
v_mfma_f32_32x32x16_bf16 v[64:79], a[236:239], v[160:163], v[64:79]
v_exp_f32 v130, v34
v_exp_f32 v131, v35
v_exp_f32 v132, v36
v_exp_f32 v133, v37
v_mfma_f32_32x32x16_bf16 v[80:95], a[236:239], v[168:171], v[80:95]
v_exp_f32 v134, v38
v_exp_f32 v135, v39
v_exp_f32 v136, v40
v_exp_f32 v137, v41
v_mfma_f32_32x32x16_bf16 v[64:79], a[240:243], v[164:167], v[64:79]
v_exp_f32 v138, v42
v_exp_f32 v139, v43
v_exp_f32 v140, v44
v_exp_f32 v141, v45
v_mfma_f32_32x32x16_bf16 v[80:95], a[240:243], v[172:175], v[80:95]
v_exp_f32 v142, v46
v_exp_f32 v143, v47
v_exp_f32 v144, v48
v_exp_f32 v145, v49
v_mfma_f32_32x32x8bf16_1k v[128:143], a[64:65], a[64:65], v[128:143]
v_exp_f32 v146, v50
v_exp_f32 v147, v51
v_exp_f32 v148, v52
v_exp_f32 v149, v53
v_exp_f32 v150, v54
v_exp_f32 v151, v55
v_exp_f32 v152, v56
v_exp_f32 v153, v57
v_exp_f32 v154, v58
v_exp_f32 v155, v59
v_exp_f32 v156, v60
v_exp_f32 v157, v61
v_exp_f32 v158, v62
v_exp_f32 v159, v63
v_rcp_f32 v128, v128
v_rcp_f32 v129, v129
v_mfma_f32_32x32x8bf16_1k v[144:159], a[64:65], a[64:65], v[144:159]
ds_read_b32 v12, v223 offset:4
v_rcp_f32 v130, v130
v_rcp_f32 v131, v131
v_rcp_f32 v132, v132
v_rcp_f32 v133, v133
v_rcp_f32 v134, v134
v_rcp_f32 v135, v135
v_rcp_f32 v136, v136
v_rcp_f32 v137, v137
v_rcp_f32 v138, v138
v_rcp_f32 v139, v139
v_rcp_f32 v140, v140
v_rcp_f32 v141, v141
v_rcp_f32 v142, v142
v_rcp_f32 v143, v143
v_rcp_f32 v144, v144
v_rcp_f32 v145, v145
v_rcp_f32 v146, v146
v_rcp_f32 v147, v147
v_rcp_f32 v148, v148
v_rcp_f32 v149, v149
v_rcp_f32 v150, v150
v_rcp_f32 v151, v151
v_rcp_f32 v152, v152
v_rcp_f32 v153, v153
v_rcp_f32 v154, v154
v_rcp_f32 v155, v155
v_rcp_f32 v156, v156
v_rcp_f32 v157, v157
v_rcp_f32 v158, v158
v_rcp_f32 v159, v159
v_pk_mul_f32 v[128:129], v[32:33], v[128:129]
v_pk_mul_f32 v[130:131], v[34:35], v[130:131]
v_pk_mul_f32 v[132:133], v[36:37], v[132:133]
v_pk_mul_f32 v[134:135], v[38:39], v[134:135]
v_pk_mul_f32 v[136:137], v[40:41], v[136:137]
v_pk_mul_f32 v[138:139], v[42:43], v[138:139]
v_pk_mul_f32 v[140:141], v[44:45], v[140:141]
v_pk_mul_f32 v[142:143], v[46:47], v[142:143]
v_pk_mul_f32 v[144:145], v[48:49], v[144:145]
v_pk_mul_f32 v[146:147], v[50:51], v[146:147]
v_pk_mul_f32 v[148:149], v[52:53], v[148:149]
v_pk_mul_f32 v[150:151], v[54:55], v[150:151]
v_pk_mul_f32 v[152:153], v[56:57], v[152:153]
v_pk_mul_f32 v[154:155], v[58:59], v[154:155]
v_pk_mul_f32 v[156:157], v[60:61], v[156:157]
v_pk_mul_f32 v[158:159], v[62:63], v[158:159]
s_waitcnt lgkmcnt(0)
v_readfirstlane_b32 s56, v12
v_cvt_pk_bf16_f32 v160, v128, v129
v_cvt_pk_bf16_f32 v161, v130, v131
v_cvt_pk_bf16_f32 v162, v132, v133
v_cvt_pk_bf16_f32 v163, v134, v135
v_cvt_pk_bf16_f32 v168, v144, v145
v_cvt_pk_bf16_f32 v169, v146, v147
v_mfma_f32_32x32x16_bf16 v[96:111], a[236:239], v[160:163], v[96:111]
s_mov_b32 s37, s36
v_cvt_pk_bf16_f32 v170, v148, v149
v_cvt_pk_bf16_f32 v171, v150, v151
v_cvt_pk_bf16_f32 v164, v136, v137
v_cvt_pk_bf16_f32 v165, v138, v139
v_cvt_pk_bf16_f32 v166, v140, v141
v_cvt_pk_bf16_f32 v167, v142, v143
v_mfma_f32_32x32x16_bf16 v[112:127], a[236:239], v[168:171], v[112:127]
s_mov_b32 s39, s36
v_cvt_pk_bf16_f32 v172, v152, v153
v_cvt_pk_bf16_f32 v173, v154, v155
v_cvt_pk_bf16_f32 v174, v156, v157
v_cvt_pk_bf16_f32 v175, v158, v159
s_mov_b32 s42, s41
s_cmp_eq_u32 s30, 3
v_mfma_f32_32x32x16_bf16 v[96:111], a[240:243], v[164:167], v[96:111]
ds_write_b64 v232, a[244:245]
ds_write_b64 v233, a[244:245]
v_mfma_f32_32x32x16_bf16 v[112:127], a[240:243], v[172:175], v[112:127]
s_cselect_b32 s56, s45, s56
s_cmp_eq_u32 s56, s45
s_cbranch_scc0 K2_FW
K2_HF:
s_add_u32 s58, s37, 31
s_mul_i32 s56, s42, 34
v_readlane_b32 s58, v247, s58
v_add_u32 v234, s56, v245
v_add_u32 v255, s56, v246
ds_read_b32 v0, v234 offset:0
ds_read_b32 v1, v234 offset:128
ds_read_b32 v2, v234 offset:544
ds_read_b32 v3, v234 offset:672
ds_read_b32 v4, v234 offset:1088
ds_read_b32 v5, v234 offset:1216
ds_read_b32 v6, v234 offset:1632
ds_read_b32 v7, v234 offset:1760
ds_read_b32 v10, v255
v_pk_mul_f32 v[176:177], v[64:65], v[224:225] op_sel:[0,0] op_sel_hi:[1,0]
v_pk_mul_f32 v[178:179], v[66:67], v[224:225] op_sel:[0,0] op_sel_hi:[1,0]
v_pk_mul_f32 v[180:181], v[68:69], v[224:225] op_sel:[0,0] op_sel_hi:[1,0]
v_pk_mul_f32 v[182:183], v[70:71], v[224:225] op_sel:[0,0] op_sel_hi:[1,0]
v_pk_mul_f32 v[184:185], v[72:73], v[224:225] op_sel:[0,0] op_sel_hi:[1,0]
v_pk_mul_f32 v[186:187], v[74:75], v[224:225] op_sel:[0,0] op_sel_hi:[1,0]
v_pk_mul_f32 v[188:189], v[76:77], v[224:225] op_sel:[0,0] op_sel_hi:[1,0]
v_pk_mul_f32 v[190:191], v[78:79], v[224:225] op_sel:[0,0] op_sel_hi:[1,0]
v_pk_fma_f32 v[176:177], v[80:81], v[224:225], v[176:177] op_sel:[0,1,0] op_sel_hi:[1,1,1]
v_pk_fma_f32 v[178:179], v[82:83], v[224:225], v[178:179] op_sel:[0,1,0] op_sel_hi:[1,1,1]
v_pk_fma_f32 v[180:181], v[84:85], v[224:225], v[180:181] op_sel:[0,1,0] op_sel_hi:[1,1,1]
v_pk_fma_f32 v[182:183], v[86:87], v[224:225], v[182:183] op_sel:[0,1,0] op_sel_hi:[1,1,1]
v_pk_fma_f32 v[184:185], v[88:89], v[224:225], v[184:185] op_sel:[0,1,0] op_sel_hi:[1,1,1]
v_pk_fma_f32 v[186:187], v[90:91], v[224:225], v[186:187] op_sel:[0,1,0] op_sel_hi:[1,1,1]
v_pk_fma_f32 v[188:189], v[92:93], v[224:225], v[188:189] op_sel:[0,1,0] op_sel_hi:[1,1,1]
v_pk_fma_f32 v[190:191], v[94:95], v[224:225], v[190:191] op_sel:[0,1,0] op_sel_hi:[1,1,1]
v_pk_fma_f32 v[176:177], v[96:97], v[226:227], v[176:177] op_sel:[0,0,0] op_sel_hi:[1,0,1]
v_pk_fma_f32 v[178:179], v[98:99], v[226:227], v[178:179] op_sel:[0,0,0] op_sel_hi:[1,0,1]
v_pk_fma_f32 v[180:181], v[100:101], v[226:227], v[180:181] op_sel:[0,0,0] op_sel_hi:[1,0,1]
v_pk_fma_f32 v[182:183], v[102:103], v[226:227], v[182:183] op_sel:[0,0,0] op_sel_hi:[1,0,1]
v_pk_fma_f32 v[184:185], v[104:105], v[226:227], v[184:185] op_sel:[0,0,0] op_sel_hi:[1,0,1]
v_pk_fma_f32 v[186:187], v[106:107], v[226:227], v[186:187] op_sel:[0,0,0] op_sel_hi:[1,0,1]
v_pk_fma_f32 v[188:189], v[108:109], v[226:227], v[188:189] op_sel:[0,0,0] op_sel_hi:[1,0,1]
v_pk_fma_f32 v[190:191], v[110:111], v[226:227], v[190:191] op_sel:[0,0,0] op_sel_hi:[1,0,1]
v_pk_fma_f32 v[176:177], v[112:113], v[226:227], v[176:177] op_sel:[0,1,0] op_sel_hi:[1,1,1]
v_pk_fma_f32 v[178:179], v[114:115], v[226:227], v[178:179] op_sel:[0,1,0] op_sel_hi:[1,1,1]
v_pk_fma_f32 v[180:181], v[116:117], v[226:227], v[180:181] op_sel:[0,1,0] op_sel_hi:[1,1,1]
v_pk_fma_f32 v[182:183], v[118:119], v[226:227], v[182:183] op_sel:[0,1,0] op_sel_hi:[1,1,1]
v_pk_fma_f32 v[184:185], v[120:121], v[226:227], v[184:185] op_sel:[0,1,0] op_sel_hi:[1,1,1]
v_pk_fma_f32 v[186:187], v[122:123], v[226:227], v[186:187] op_sel:[0,1,0] op_sel_hi:[1,1,1]
v_pk_fma_f32 v[188:189], v[124:125], v[226:227], v[188:189] op_sel:[0,1,0] op_sel_hi:[1,1,1]
v_pk_fma_f32 v[190:191], v[126:127], v[226:227], v[190:191] op_sel:[0,1,0] op_sel_hi:[1,1,1]
s_sub_u32 s58, s58, s42
s_mul_i32 s59, s58, 34
s_lshl_b32 s58, s58, 1
s_add_u32 s59, s59, 70332
s_sub_i32 s76, s58, 32
s_sub_i32 s77, s58, 64
s_sub_i32 s78, s58, 96
v_mov_b32 v9, s45
v_cvt_pk_bf16_f32 v160, v176, v177
v_cvt_pk_bf16_f32 v161, v178, v179
v_cvt_pk_bf16_f32 v162, v180, v181
v_cvt_pk_bf16_f32 v163, v182, v183
v_cvt_pk_bf16_f32 v164, v184, v185
v_cvt_pk_bf16_f32 v165, v186, v187
v_cvt_pk_bf16_f32 v166, v188, v189
v_cvt_pk_bf16_f32 v167, v190, v191
s_waitcnt lgkmcnt(0)
v_dot2_f32_bf16 v67, v0, s65, v67
v_dot2_f32_bf16 v83, v0, s66, v83
v_mfma_f32_32x32x16_bf16 v[176:191], v[160:163], a[248:251], 0
v_dot2_f32_bf16 v71, v2, s65, v71
v_dot2_f32_bf16 v87, v2, s66, v87
v_dot2_f32_bf16 v75, v4, s65, v75
v_dot2_f32_bf16 v91, v4, s66, v91
v_dot2_f32_bf16 v79, v6, s65, v79
v_dot2_f32_bf16 v95, v6, s66, v95
v_mfma_f32_32x32x16_bf16 v[176:191], v[164:167], a[252:255], v[176:191]
v_dot2_f32_bf16 v99, v1, s65, v99
v_dot2_f32_bf16 v115, v1, s66, v115
v_dot2_f32_bf16 v103, v3, s65, v103
v_dot2_f32_bf16 v119, v3, s66, v119
v_dot2_f32_bf16 v107, v5, s65, v107
v_dot2_f32_bf16 v123, v5, s66, v123
v_dot2_f32_bf16 v111, v7, s65, v111
v_dot2_f32_bf16 v127, v7, s66, v127
v_cmp_ge_i32 s[70:71], s58, v238
v_cmp_ge_i32 s[72:73], s76, v238
v_cmp_ge_i32 s[60:61], s77, v238
v_cmp_ge_i32 s[62:63], s78, v238
v_cmp_ge_u32 vcc, s59, v246
v_cvt_pk_bf16_f32 v168, v67, v83
v_cvt_pk_bf16_f32 v169, v71, v87
v_cvt_pk_bf16_f32 v170, v75, v91
v_cvt_pk_bf16_f32 v171, v79, v95
v_cvt_pk_bf16_f32 v172, v99, v115
v_cvt_pk_bf16_f32 v173, v103, v119
v_cvt_pk_bf16_f32 v174, v107, v123
v_cvt_pk_bf16_f32 v175, v111, v127
v_add_f32 v176, v176, v184
v_add_f32 v177, v177, v185
v_add_f32 v178, v178, v186
v_add_f32 v179, v179, v187
v_add_f32 v180, v180, v188
v_add_f32 v181, v181, v189
v_add_f32 v182, v182, v190
v_add_f32 v183, v183, v191
v_add_f32 v176, v176, v180
v_add_f32 v177, v177, v181
v_add_f32 v178, v178, v182
v_add_f32 v179, v179, v183
v_add_f32 v176, v176, v178
v_add_f32 v177, v177, v179
v_add_f32 v176, v176, v177
v_mov_b32 v11, v176
s_mov_b64 exec, s[70:71]
ds_write_b32 v234, v168 offset:0
ds_write_b32 v234, v172 offset:128
s_mov_b64 exec, s[72:73]
ds_write_b32 v234, v169 offset:544
ds_write_b32 v234, v173 offset:672
s_mov_b64 exec, s[60:61]
ds_write_b32 v234, v170 offset:1088
ds_write_b32 v234, v174 offset:1216
s_mov_b64 exec, s[62:63]
ds_write_b32 v234, v171 offset:1632
ds_write_b32 v234, v175 offset:1760
s_mov_b64 exec, -1
s_cmp_eq_u32 s37, s36
v_permlane32_swap_b32 v11, v176
v_add_f32 v10, v10, v11
v_add_f32 v10, v10, v176
s_mov_b64 exec, vcc
ds_write_b32 v255, v10
s_mov_b64 exec, 1
ds_write_b32 v223, v9
s_mov_b64 exec, -1
s_cbranch_scc0 K2_HZ
K2_REND:
s_add_u32 s31, s31, s33
s_movk_i32 s34, 1792
v_and_b32 v252, 63, v254
v_and_b32 v212, 31, v252
v_lshl_add_u32 v212, s30, 5, v212
v_mul_u32_u24 v215, 272, v212
v_add_u32 v215, 70064, v215
v_add_u32 v213, v238, v215
v_lshlrev_b32 v214, 4, v212
v_bfe_u32 v253, v252, 2, 1
v_mul_u32_u24 v208, 16512, v253
v_bfe_u32 v253, v252, 3, 1
v_mul_u32_u24 v253, 320, v253
v_lshl_add_u32 v253, v238, 6, v253
v_add_u32 v208, v208, v253
v_bfe_u32 v253, v252, 4, 1
v_lshl_or_b32 v208, v253, 5, v208
v_and_b32 v253, 1, v252
v_lshl_or_b32 v208, v253, 4, v208
v_bfe_u32 v253, v252, 1, 1
v_lshl_or_b32 v208, v253, 3, v208
v_add_u32 v208, 98304, v208
v_xor_b32 v209, 64, v208
v_xor_b32 v210, 0x80, v208
v_xor_b32 v211, 0xc0, v208
s_cmp_lt_u32 s31, s32
s_waitcnt vmcnt(0) lgkmcnt(0)
s_barrier
s_cbranch_scc1 K2_ROUND
ds_read_b128 v[64:67], v213 offset:0
ds_read_b64_tr_b16 a[64:65], v208 offset:0
ds_read_b64_tr_b16 a[66:67], v208 offset:512
ds_read_b128 v[68:71], v213 offset:32
ds_read_b64_tr_b16 a[68:69], v208 offset:2048
ds_read_b64_tr_b16 a[70:71], v208 offset:2560
ds_read_b128 v[72:75], v213 offset:64
ds_read_b64_tr_b16 a[72:73], v208 offset:4096
ds_read_b64_tr_b16 a[74:75], v208 offset:4608
ds_read_b128 v[76:79], v213 offset:96
ds_read_b64_tr_b16 a[76:77], v208 offset:6144
ds_read_b64_tr_b16 a[78:79], v208 offset:6656
ds_read_b128 v[80:83], v213 offset:128
ds_read_b128 v[84:87], v213 offset:160
ds_read_b128 v[88:91], v213 offset:192
ds_read_b128 v[92:95], v213 offset:224
v_mfma_f32_32x32x16_bf16 v[128:143], a[248:251], a[192:195], 0
v_accvgpr_read_b32 v0, a0
v_accvgpr_read_b32 v1, a1
v_accvgpr_read_b32 v2, a2
v_accvgpr_read_b32 v3, a3
v_accvgpr_read_b32 v4, a4
v_accvgpr_read_b32 v5, a5
v_accvgpr_read_b32 v6, a6
v_accvgpr_read_b32 v7, a7
v_mfma_f32_32x32x16_bf16 v[128:143], a[252:255], a[196:199], v[128:143]
v_accvgpr_read_b32 v8, a8
v_accvgpr_read_b32 v9, a9
v_accvgpr_read_b32 v10, a10
v_accvgpr_read_b32 v11, a11
v_accvgpr_read_b32 v12, a12
v_accvgpr_read_b32 v13, a13
v_accvgpr_read_b32 v14, a14
v_accvgpr_read_b32 v15, a15
s_nop 0
s_waitcnt lgkmcnt(13)
v_mfma_f32_32x32x16_bf16 v[0:15], a[64:67], v[64:67], v[0:15]
ds_read_b64_tr_b16 a[80:81], v208 offset:32768
ds_read_b64_tr_b16 a[82:83], v208 offset:33280
v_accvgpr_read_b32 v16, a16
v_accvgpr_read_b32 v17, a17
v_accvgpr_read_b32 v18, a18
v_accvgpr_read_b32 v19, a19
v_accvgpr_read_b32 v20, a20
v_accvgpr_read_b32 v21, a21
s_waitcnt lgkmcnt(12)
v_mfma_f32_32x32x16_bf16 v[0:15], a[68:71], v[68:71], v[0:15]
ds_read_b64_tr_b16 a[84:85], v208 offset:34816
ds_read_b64_tr_b16 a[86:87], v208 offset:35328
v_accvgpr_read_b32 v22, a22
v_accvgpr_read_b32 v23, a23
v_accvgpr_read_b32 v24, a24
v_accvgpr_read_b32 v25, a25
v_accvgpr_read_b32 v26, a26
v_accvgpr_read_b32 v27, a27
s_waitcnt lgkmcnt(11)
v_mfma_f32_32x32x16_bf16 v[0:15], a[72:75], v[72:75], v[0:15]
ds_read_b64_tr_b16 a[88:89], v208 offset:36864
ds_read_b64_tr_b16 a[90:91], v208 offset:37376
v_accvgpr_read_b32 v28, a28
v_accvgpr_read_b32 v29, a29
v_accvgpr_read_b32 v30, a30
v_accvgpr_read_b32 v31, a31
ds_read_b96 v[200:202], v214 offset:0
ds_read_b96 v[204:206], v215 offset:256
s_waitcnt lgkmcnt(12)
v_mfma_f32_32x32x16_bf16 v[0:15], a[76:79], v[76:79], v[0:15]
ds_read_b64_tr_b16 a[92:93], v208 offset:38912
ds_read_b64_tr_b16 a[94:95], v208 offset:39424
v_add_u32 v199, s28, v212
v_mul_u32_u24 v197, 6, v199
v_add_u32 v197, 6400000, v197
v_cmp_gt_u32 vcc, s29, v212
v_bfrev_b32 v198, 2
v_lshl_add_u32 v199, v199, 8, v238
s_waitcnt lgkmcnt(8)
v_mfma_f32_32x32x16_bf16 v[0:15], a[80:83], v[80:83], v[0:15]
ds_read_b64_tr_b16 a[96:97], v209 offset:0
ds_read_b64_tr_b16 a[98:99], v209 offset:512
v_lshl_add_u32 v197, v238, 26, v197
v_cndmask_b32 v199, v198, v199, vcc
v_cndmask_b32 v197, v198, v197, vcc
s_mov_b32 s58, 3216550459
s_mov_b32 s59, 3216550459
v_accvgpr_read_b32 v32, a32
s_waitcnt lgkmcnt(8)
v_mfma_f32_32x32x16_bf16 v[0:15], a[84:87], v[84:87], v[0:15]
ds_read_b64_tr_b16 a[100:101], v209 offset:2048
ds_read_b64_tr_b16 a[102:103], v209 offset:2560
v_accvgpr_read_b32 v33, a33
v_accvgpr_read_b32 v34, a34
v_accvgpr_read_b32 v35, a35
v_accvgpr_read_b32 v36, a36
v_accvgpr_read_b32 v37, a37
v_accvgpr_read_b32 v38, a38
s_waitcnt lgkmcnt(8)
v_mfma_f32_32x32x16_bf16 v[0:15], a[88:91], v[88:91], v[0:15]
ds_read_b64_tr_b16 a[104:105], v209 offset:4096
ds_read_b64_tr_b16 a[106:107], v209 offset:4608
v_accvgpr_read_b32 v39, a39
v_accvgpr_read_b32 v40, a40
v_accvgpr_read_b32 v41, a41
v_accvgpr_read_b32 v42, a42
v_accvgpr_read_b32 v43, a43
v_accvgpr_read_b32 v44, a44
s_waitcnt lgkmcnt(6)
v_mfma_f32_32x32x16_bf16 v[0:15], a[92:95], v[92:95], v[0:15]
ds_read_b64_tr_b16 a[108:109], v209 offset:6144
ds_read_b64_tr_b16 a[110:111], v209 offset:6656
v_accvgpr_read_b32 v45, a45
v_accvgpr_read_b32 v46, a46
v_accvgpr_read_b32 v47, a47
s_waitcnt lgkmcnt(10)
v_add_f32 v200, v200, v204
v_add_f32 v201, v201, v205
v_mfma_f32_32x32x16_bf16 v[144:159], a[248:251], a[200:203], 0
v_add_f32 v202, v202, v206
v_cvt_pk_bf16_f32 v200, v200, v201
v_cvt_pk_bf16_f32 v202, v202, v202
buffer_store_short v200, v197, s[20:23], 0 offen
buffer_store_short_d16_hi v200, v197, s[20:23], 0 offen offset:2
buffer_store_short v202, v197, s[20:23], 0 offen offset:4
v_mfma_f32_32x32x16_bf16 v[144:159], a[252:255], a[204:207], v[144:159]
v_accvgpr_read_b32 v48, a48
v_accvgpr_read_b32 v49, a49
v_accvgpr_read_b32 v50, a50
v_accvgpr_read_b32 v51, a51
v_accvgpr_read_b32 v52, a52
v_accvgpr_read_b32 v53, a53
s_waitcnt lgkmcnt(6)
v_mfma_f32_32x32x16_bf16 v[16:31], a[96:99], v[64:67], v[16:31]
ds_read_b64_tr_b16 a[112:113], v209 offset:32768
ds_read_b64_tr_b16 a[114:115], v209 offset:33280
v_accvgpr_read_b32 v54, a54
v_accvgpr_read_b32 v55, a55
v_accvgpr_read_b32 v56, a56
v_accvgpr_read_b32 v57, a57
v_accvgpr_read_b32 v58, a58
v_accvgpr_read_b32 v59, a59
v_accvgpr_read_b32 v60, a60
v_accvgpr_read_b32 v61, a61
v_accvgpr_read_b32 v62, a62
v_accvgpr_read_b32 v63, a63
s_waitcnt lgkmcnt(6)
v_mfma_f32_32x32x16_bf16 v[16:31], a[100:103], v[68:71], v[16:31]
ds_read_b64_tr_b16 a[116:117], v209 offset:34816
ds_read_b64_tr_b16 a[118:119], v209 offset:35328
v_exp_f32 v96, v0
v_exp_f32 v97, v1
v_exp_f32 v98, v2
v_exp_f32 v99, v3
v_exp_f32 v100, v4
s_waitcnt lgkmcnt(6)
v_mfma_f32_32x32x16_bf16 v[16:31], a[104:107], v[72:75], v[16:31]
ds_read_b64_tr_b16 a[120:121], v209 offset:36864
ds_read_b64_tr_b16 a[122:123], v209 offset:37376
v_exp_f32 v101, v5
v_exp_f32 v102, v6
v_exp_f32 v103, v7
v_exp_f32 v104, v8
v_exp_f32 v105, v9
s_waitcnt lgkmcnt(6)
v_mfma_f32_32x32x16_bf16 v[16:31], a[108:111], v[76:79], v[16:31]
ds_read_b64_tr_b16 a[124:125], v209 offset:38912
ds_read_b64_tr_b16 a[126:127], v209 offset:39424
v_exp_f32 v106, v10
v_exp_f32 v107, v11
v_exp_f32 v108, v12
v_exp_f32 v109, v13
v_exp_f32 v110, v14
s_waitcnt lgkmcnt(6)
v_mfma_f32_32x32x16_bf16 v[16:31], a[112:115], v[80:83], v[16:31]
ds_read_b64_tr_b16 a[64:65], v210 offset:0
ds_read_b64_tr_b16 a[66:67], v210 offset:512
v_exp_f32 v111, v15
v_pk_fma_f32 v[96:97], v[96:97], s[58:59], s[58:59]
v_pk_fma_f32 v[98:99], v[98:99], s[58:59], s[58:59]
v_pk_fma_f32 v[100:101], v[100:101], s[58:59], s[58:59]
v_pk_fma_f32 v[102:103], v[102:103], s[58:59], s[58:59]
v_pk_fma_f32 v[104:105], v[104:105], s[58:59], s[58:59]
v_pk_fma_f32 v[106:107], v[106:107], s[58:59], s[58:59]
v_pk_fma_f32 v[108:109], v[108:109], s[58:59], s[58:59]
v_pk_fma_f32 v[110:111], v[110:111], s[58:59], s[58:59]
s_waitcnt lgkmcnt(6)
v_mfma_f32_32x32x16_bf16 v[16:31], a[116:119], v[84:87], v[16:31]
ds_read_b64_tr_b16 a[68:69], v210 offset:2048
ds_read_b64_tr_b16 a[70:71], v210 offset:2560
v_rcp_f32 v96, v96
v_rcp_f32 v97, v97
v_rcp_f32 v98, v98
v_rcp_f32 v99, v99
v_rcp_f32 v100, v100
s_waitcnt lgkmcnt(6)
v_mfma_f32_32x32x16_bf16 v[16:31], a[120:123], v[88:91], v[16:31]
ds_read_b64_tr_b16 a[72:73], v210 offset:4096
ds_read_b64_tr_b16 a[74:75], v210 offset:4608
v_rcp_f32 v101, v101
v_rcp_f32 v102, v102
v_rcp_f32 v103, v103
v_rcp_f32 v104, v104
v_rcp_f32 v105, v105
s_waitcnt lgkmcnt(6)
v_mfma_f32_32x32x16_bf16 v[16:31], a[124:127], v[92:95], v[16:31]
ds_read_b64_tr_b16 a[76:77], v210 offset:6144
ds_read_b64_tr_b16 a[78:79], v210 offset:6656
v_rcp_f32 v106, v106
v_rcp_f32 v107, v107
v_rcp_f32 v108, v108
v_rcp_f32 v109, v109
v_rcp_f32 v110, v110
v_mfma_f32_32x32x16_bf16 v[160:175], a[248:251], a[208:211], 0
v_rcp_f32 v111, v111
v_pk_fma_f32 v[96:97], v[0:1], v[96:97], v[128:129]
v_pk_fma_f32 v[98:99], v[2:3], v[98:99], v[130:131]
v_pk_fma_f32 v[100:101], v[4:5], v[100:101], v[132:133]
v_pk_fma_f32 v[102:103], v[6:7], v[102:103], v[134:135]
v_pk_fma_f32 v[104:105], v[8:9], v[104:105], v[136:137]
v_pk_fma_f32 v[106:107], v[10:11], v[106:107], v[138:139]
v_pk_fma_f32 v[108:109], v[12:13], v[108:109], v[140:141]
v_pk_fma_f32 v[110:111], v[14:15], v[110:111], v[142:143]
v_mfma_f32_32x32x16_bf16 v[160:175], a[252:255], a[212:215], v[160:175]
v_cvt_pk_bf16_f32 v112, v96, v97
v_cvt_pk_bf16_f32 v113, v98, v99
v_cvt_pk_bf16_f32 v114, v100, v101
v_cvt_pk_bf16_f32 v115, v102, v103
v_cvt_pk_bf16_f32 v116, v104, v105
v_cvt_pk_bf16_f32 v117, v106, v107
v_cvt_pk_bf16_f32 v118, v108, v109
v_cvt_pk_bf16_f32 v119, v110, v111
buffer_store_dwordx4 v[112:115], v199, s[20:23], 0 offen offset:0
buffer_store_dwordx4 v[116:119], v199, s[20:23], 0 offen offset:32
s_waitcnt lgkmcnt(6)
v_mfma_f32_32x32x16_bf16 v[32:47], a[64:67], v[64:67], v[32:47]
ds_read_b64_tr_b16 a[80:81], v210 offset:32768
ds_read_b64_tr_b16 a[82:83], v210 offset:33280
v_exp_f32 v96, v16
v_exp_f32 v97, v17
v_exp_f32 v98, v18
v_exp_f32 v99, v19
v_exp_f32 v100, v20
s_waitcnt lgkmcnt(6)
v_mfma_f32_32x32x16_bf16 v[32:47], a[68:71], v[68:71], v[32:47]
ds_read_b64_tr_b16 a[84:85], v210 offset:34816
ds_read_b64_tr_b16 a[86:87], v210 offset:35328
v_exp_f32 v101, v21
v_exp_f32 v102, v22
v_exp_f32 v103, v23
v_exp_f32 v104, v24
v_exp_f32 v105, v25
s_waitcnt lgkmcnt(6)
v_mfma_f32_32x32x16_bf16 v[32:47], a[72:75], v[72:75], v[32:47]
ds_read_b64_tr_b16 a[88:89], v210 offset:36864
ds_read_b64_tr_b16 a[90:91], v210 offset:37376
v_exp_f32 v106, v26
v_exp_f32 v107, v27
v_exp_f32 v108, v28
v_exp_f32 v109, v29
v_exp_f32 v110, v30
s_waitcnt lgkmcnt(6)
v_mfma_f32_32x32x16_bf16 v[32:47], a[76:79], v[76:79], v[32:47]
ds_read_b64_tr_b16 a[92:93], v210 offset:38912
ds_read_b64_tr_b16 a[94:95], v210 offset:39424
v_exp_f32 v111, v31
v_pk_fma_f32 v[96:97], v[96:97], s[58:59], s[58:59]
v_pk_fma_f32 v[98:99], v[98:99], s[58:59], s[58:59]
v_pk_fma_f32 v[100:101], v[100:101], s[58:59], s[58:59]
v_pk_fma_f32 v[102:103], v[102:103], s[58:59], s[58:59]
v_pk_fma_f32 v[104:105], v[104:105], s[58:59], s[58:59]
v_pk_fma_f32 v[106:107], v[106:107], s[58:59], s[58:59]
v_pk_fma_f32 v[108:109], v[108:109], s[58:59], s[58:59]
v_pk_fma_f32 v[110:111], v[110:111], s[58:59], s[58:59]
s_waitcnt lgkmcnt(6)
v_mfma_f32_32x32x16_bf16 v[32:47], a[80:83], v[80:83], v[32:47]
ds_read_b64_tr_b16 a[96:97], v211 offset:0
ds_read_b64_tr_b16 a[98:99], v211 offset:512
v_rcp_f32 v96, v96
v_rcp_f32 v97, v97
v_rcp_f32 v98, v98
v_rcp_f32 v99, v99
v_rcp_f32 v100, v100
s_waitcnt lgkmcnt(6)
v_mfma_f32_32x32x16_bf16 v[32:47], a[84:87], v[84:87], v[32:47]
ds_read_b64_tr_b16 a[100:101], v211 offset:2048
ds_read_b64_tr_b16 a[102:103], v211 offset:2560
v_rcp_f32 v101, v101
v_rcp_f32 v102, v102
v_rcp_f32 v103, v103
v_rcp_f32 v104, v104
v_rcp_f32 v105, v105
s_waitcnt lgkmcnt(6)
v_mfma_f32_32x32x16_bf16 v[32:47], a[88:91], v[88:91], v[32:47]
ds_read_b64_tr_b16 a[104:105], v211 offset:4096
ds_read_b64_tr_b16 a[106:107], v211 offset:4608
v_rcp_f32 v106, v106
v_rcp_f32 v107, v107
v_rcp_f32 v108, v108
v_rcp_f32 v109, v109
v_rcp_f32 v110, v110
s_waitcnt lgkmcnt(6)
v_mfma_f32_32x32x16_bf16 v[32:47], a[92:95], v[92:95], v[32:47]
ds_read_b64_tr_b16 a[108:109], v211 offset:6144
ds_read_b64_tr_b16 a[110:111], v211 offset:6656
v_rcp_f32 v111, v111
v_pk_fma_f32 v[96:97], v[16:17], v[96:97], v[144:145]
v_pk_fma_f32 v[98:99], v[18:19], v[98:99], v[146:147]
v_pk_fma_f32 v[100:101], v[20:21], v[100:101], v[148:149]
v_pk_fma_f32 v[102:103], v[22:23], v[102:103], v[150:151]
v_pk_fma_f32 v[104:105], v[24:25], v[104:105], v[152:153]
v_pk_fma_f32 v[106:107], v[26:27], v[106:107], v[154:155]
v_pk_fma_f32 v[108:109], v[28:29], v[108:109], v[156:157]
v_pk_fma_f32 v[110:111], v[30:31], v[110:111], v[158:159]
v_mfma_f32_32x32x16_bf16 v[176:191], a[248:251], a[216:219], 0
v_cvt_pk_bf16_f32 v120, v96, v97
v_cvt_pk_bf16_f32 v121, v98, v99
v_cvt_pk_bf16_f32 v122, v100, v101
v_cvt_pk_bf16_f32 v123, v102, v103
v_cvt_pk_bf16_f32 v124, v104, v105
v_cvt_pk_bf16_f32 v125, v106, v107
v_cvt_pk_bf16_f32 v126, v108, v109
v_cvt_pk_bf16_f32 v127, v110, v111
buffer_store_dwordx4 v[120:123], v199, s[20:23], 0 offen offset:64
buffer_store_dwordx4 v[124:127], v199, s[20:23], 0 offen offset:96
v_mfma_f32_32x32x16_bf16 v[176:191], a[252:255], a[220:223], v[176:191]
s_waitcnt lgkmcnt(6)
v_mfma_f32_32x32x16_bf16 v[48:63], a[96:99], v[64:67], v[48:63]
ds_read_b64_tr_b16 a[112:113], v211 offset:32768
ds_read_b64_tr_b16 a[114:115], v211 offset:33280
v_exp_f32 v96, v32
v_exp_f32 v97, v33
v_exp_f32 v98, v34
v_exp_f32 v99, v35
v_exp_f32 v100, v36
s_waitcnt lgkmcnt(6)
v_mfma_f32_32x32x16_bf16 v[48:63], a[100:103], v[68:71], v[48:63]
ds_read_b64_tr_b16 a[116:117], v211 offset:34816
ds_read_b64_tr_b16 a[118:119], v211 offset:35328
v_exp_f32 v101, v37
v_exp_f32 v102, v38
v_exp_f32 v103, v39
v_exp_f32 v104, v40
v_exp_f32 v105, v41
s_waitcnt lgkmcnt(6)
v_mfma_f32_32x32x16_bf16 v[48:63], a[104:107], v[72:75], v[48:63]
ds_read_b64_tr_b16 a[120:121], v211 offset:36864
ds_read_b64_tr_b16 a[122:123], v211 offset:37376
v_exp_f32 v106, v42
v_exp_f32 v107, v43
v_exp_f32 v108, v44
v_exp_f32 v109, v45
v_exp_f32 v110, v46
s_waitcnt lgkmcnt(6)
v_mfma_f32_32x32x16_bf16 v[48:63], a[108:111], v[76:79], v[48:63]
ds_read_b64_tr_b16 a[124:125], v211 offset:38912
ds_read_b64_tr_b16 a[126:127], v211 offset:39424
v_exp_f32 v111, v47
v_pk_fma_f32 v[96:97], v[96:97], s[58:59], s[58:59]
v_pk_fma_f32 v[98:99], v[98:99], s[58:59], s[58:59]
v_pk_fma_f32 v[100:101], v[100:101], s[58:59], s[58:59]
v_pk_fma_f32 v[102:103], v[102:103], s[58:59], s[58:59]
v_pk_fma_f32 v[104:105], v[104:105], s[58:59], s[58:59]
v_pk_fma_f32 v[106:107], v[106:107], s[58:59], s[58:59]
v_pk_fma_f32 v[108:109], v[108:109], s[58:59], s[58:59]
v_pk_fma_f32 v[110:111], v[110:111], s[58:59], s[58:59]
s_waitcnt lgkmcnt(6)
v_mfma_f32_32x32x16_bf16 v[48:63], a[112:115], v[80:83], v[48:63]
v_rcp_f32 v96, v96
v_rcp_f32 v97, v97
v_rcp_f32 v98, v98
v_rcp_f32 v99, v99
v_rcp_f32 v100, v100
s_waitcnt lgkmcnt(4)
v_mfma_f32_32x32x16_bf16 v[48:63], a[116:119], v[84:87], v[48:63]
v_rcp_f32 v101, v101
v_rcp_f32 v102, v102
v_rcp_f32 v103, v103
v_rcp_f32 v104, v104
v_rcp_f32 v105, v105
s_waitcnt lgkmcnt(2)
v_mfma_f32_32x32x16_bf16 v[48:63], a[120:123], v[88:91], v[48:63]
v_rcp_f32 v106, v106
v_rcp_f32 v107, v107
v_rcp_f32 v108, v108
v_rcp_f32 v109, v109
v_rcp_f32 v110, v110
s_waitcnt lgkmcnt(0)
v_mfma_f32_32x32x16_bf16 v[48:63], a[124:127], v[92:95], v[48:63]
v_rcp_f32 v111, v111
v_pk_fma_f32 v[96:97], v[32:33], v[96:97], v[160:161]
v_pk_fma_f32 v[98:99], v[34:35], v[98:99], v[162:163]
v_pk_fma_f32 v[100:101], v[36:37], v[100:101], v[164:165]
v_pk_fma_f32 v[102:103], v[38:39], v[102:103], v[166:167]
v_pk_fma_f32 v[104:105], v[40:41], v[104:105], v[168:169]
v_pk_fma_f32 v[106:107], v[42:43], v[106:107], v[170:171]
v_pk_fma_f32 v[108:109], v[44:45], v[108:109], v[172:173]
v_pk_fma_f32 v[110:111], v[46:47], v[110:111], v[174:175]
v_cvt_pk_bf16_f32 v112, v96, v97
v_cvt_pk_bf16_f32 v113, v98, v99
v_cvt_pk_bf16_f32 v114, v100, v101
v_cvt_pk_bf16_f32 v115, v102, v103
v_cvt_pk_bf16_f32 v116, v104, v105
v_cvt_pk_bf16_f32 v117, v106, v107
v_cvt_pk_bf16_f32 v118, v108, v109
v_cvt_pk_bf16_f32 v119, v110, v111
buffer_store_dwordx4 v[112:115], v199, s[20:23], 0 offen offset:128
buffer_store_dwordx4 v[116:119], v199, s[20:23], 0 offen offset:160
v_exp_f32 v96, v48
v_exp_f32 v97, v49
v_exp_f32 v98, v50
v_exp_f32 v99, v51
v_exp_f32 v100, v52
v_exp_f32 v101, v53
v_exp_f32 v102, v54
v_exp_f32 v103, v55
v_exp_f32 v104, v56
v_exp_f32 v105, v57
v_exp_f32 v106, v58
v_exp_f32 v107, v59
v_exp_f32 v108, v60
v_exp_f32 v109, v61
v_exp_f32 v110, v62
v_exp_f32 v111, v63
v_pk_fma_f32 v[96:97], v[96:97], s[58:59], s[58:59]
v_pk_fma_f32 v[98:99], v[98:99], s[58:59], s[58:59]
v_pk_fma_f32 v[100:101], v[100:101], s[58:59], s[58:59]
v_pk_fma_f32 v[102:103], v[102:103], s[58:59], s[58:59]
v_pk_fma_f32 v[104:105], v[104:105], s[58:59], s[58:59]
v_pk_fma_f32 v[106:107], v[106:107], s[58:59], s[58:59]
v_pk_fma_f32 v[108:109], v[108:109], s[58:59], s[58:59]
v_pk_fma_f32 v[110:111], v[110:111], s[58:59], s[58:59]
v_rcp_f32 v96, v96
v_rcp_f32 v97, v97
v_rcp_f32 v98, v98
v_rcp_f32 v99, v99
v_rcp_f32 v100, v100
v_rcp_f32 v101, v101
v_rcp_f32 v102, v102
v_rcp_f32 v103, v103
v_rcp_f32 v104, v104
v_rcp_f32 v105, v105
v_rcp_f32 v106, v106
v_rcp_f32 v107, v107
v_rcp_f32 v108, v108
v_rcp_f32 v109, v109
v_rcp_f32 v110, v110
v_rcp_f32 v111, v111
v_pk_fma_f32 v[96:97], v[48:49], v[96:97], v[176:177]
v_pk_fma_f32 v[98:99], v[50:51], v[98:99], v[178:179]
v_pk_fma_f32 v[100:101], v[52:53], v[100:101], v[180:181]
v_pk_fma_f32 v[102:103], v[54:55], v[102:103], v[182:183]
v_pk_fma_f32 v[104:105], v[56:57], v[104:105], v[184:185]
v_pk_fma_f32 v[106:107], v[58:59], v[106:107], v[186:187]
v_pk_fma_f32 v[108:109], v[60:61], v[108:109], v[188:189]
v_pk_fma_f32 v[110:111], v[62:63], v[110:111], v[190:191]
v_cvt_pk_bf16_f32 v120, v96, v97
v_cvt_pk_bf16_f32 v121, v98, v99
v_cvt_pk_bf16_f32 v122, v100, v101
v_cvt_pk_bf16_f32 v123, v102, v103
v_cvt_pk_bf16_f32 v124, v104, v105
v_cvt_pk_bf16_f32 v125, v106, v107
v_cvt_pk_bf16_f32 v126, v108, v109
v_cvt_pk_bf16_f32 v127, v110, v111
buffer_store_dwordx4 v[120:123], v199, s[20:23], 0 offen offset:192
buffer_store_dwordx4 v[124:127], v199, s[20:23], 0 offen offset:224
K2_END:
s_endpgm
K2_RARE:
K2_TGW:
s_sub_u32 s41, s41, 1
s_cbranch_scc1 K2_TGD
buffer_load_dwordx2 v[32:33], v3, s[80:83], 0 offen sc1
s_waitcnt vmcnt(0)
s_branch K2_TG
K2_PW:
s_sub_u32 s41, s41, 1
s_cbranch_scc1 K2_PX
buffer_load_dwordx2 v[8:9], v37, s[16:19], s56 offen sc1
s_waitcnt vmcnt(0)
s_branch K2_PC
K2_PX:
s_mov_b64 exec, -1
v_mov_b32 v8, 0
s_branch K2_PD
K2_FW:
ds_read_b32 v12, v223 offset:4
s_waitcnt lgkmcnt(0)
v_readfirstlane_b32 s56, v12
s_cmp_eq_u32 s56, s45
s_cbranch_scc0 K2_FW
s_branch K2_HF
K2_HZ:
v_mfma_f32_32x32x16_bf16 v[64:79], a[244:247], a[244:247], 0
v_mfma_f32_32x32x16_bf16 v[80:95], a[244:247], a[244:247], 0
v_mfma_f32_32x32x16_bf16 v[96:111], a[244:247], a[244:247], 0
v_mfma_f32_32x32x16_bf16 v[112:127], a[244:247], a[244:247], 0
s_branch K2_NOFL
K2_FW2:
s_sub_u32 s41, s41, 1
s_cbranch_scc1 K2_FD
s_mov_b32 s59, 524288
buffer_load_dwordx4 v[148:151], v1, s[16:19], s59 offen sc1
buffer_load_dwordx4 v[156:159], v1, s[16:19], s59 offen offset:1024 sc1
s_waitcnt vmcnt(0)
v_xor_b32 v148, s39, v148
v_xor_b32 v149, s38, v149
v_xor_b32 v150, s39, v150
v_xor_b32 v151, s38, v151
v_xor_b32 v156, s39, v156
v_xor_b32 v157, s38, v157
v_xor_b32 v158, s39, v158
v_xor_b32 v159, s38, v159
v_or3_b32 v148, v148, v149, v150
v_or3_b32 v156, v156, v157, v158
v_or3_b32 v148, v148, v151, v159
v_or_b32 v148, v148, v156
v_cmp_ne_u32 vcc, 0, v148
s_cmp_eq_u64 vcc, 0
s_cbranch_scc0 K2_FW2
s_branch K2_FD
K2_NY:
s_waitcnt vmcnt(0)
s_branch K2_YD
K2_ROUND:
v_and_b32 v4, 63, v254
v_mov_b32 v8, 0
v_mov_b32 v9, 0
v_mov_b32 v10, 0
v_mov_b32 v11, 0
v_lshlrev_b32 v1, 4, v4
v_lshlrev_b32 v28, 3, v4
v_add_u32 v2, s52, v1
ds_write_b128 v2, v[8:11]
ds_write_b128 v2, v[8:11] offset:1024
ds_write_b64 v28, v[8:9] offset:30240
v_and_b32 v5, 31, v4
v_lshrrev_b32 v6, 5, v4
v_lshl_add_u32 v47, v4, 2, s52
v_add_u32 v22, 96768, v1
s_lshl_b32 s56, s30, 11
s_add_u32 s56, s56, 61872
v_lshl_add_u32 v231, v5, 6, s56
v_lshl_add_u32 v232, v5, 6, s56
v_lshl_add_u32 v233, v5, 6, s56
s_add_u32 s45, s31, 1
s_mov_b32 s6, s54
s_mov_b32 s10, s55
s_mov_b32 s26, 0
s_waitcnt lgkmcnt(0)
s_branch K2_R1
K2_PAD:
s_waitcnt lgkmcnt(0)
s_barrier
v_cmp_gt_u32 vcc, 49, v4
v_add_u32 v60, 3, v36
v_add_u32 v61, 3, v37
v_and_b32 v60, -4, v60
v_and_b32 v61, -4, v61
v_max_u32 v60, 4, v60
v_max_u32 v61, 4, v61
v_cndmask_b32 v60, 0, v60, vcc
v_cndmask_b32 v61, 0, v61, vcc
v_add_u32 v38, v60, v61
v_mov_b32 v39, v38
s_nop 1
v_add_u32_dpp v39, v39, v39 row_shr:1 row_mask:0xf bank_mask:0xf bound_ctrl:0
s_nop 1
v_add_u32_dpp v39, v39, v39 row_shr:2 row_mask:0xf bank_mask:0xf bound_ctrl:0
s_nop 1
v_add_u32_dpp v39, v39, v39 row_shr:4 row_mask:0xf bank_mask:0xf bound_ctrl:0
s_nop 1
v_add_u32_dpp v39, v39, v39 row_shr:8 row_mask:0xf bank_mask:0xf bound_ctrl:0
s_nop 1
v_add_u32_dpp v39, v39, v39 row_bcast:15 row_mask:0xa bank_mask:0xf
s_nop 1
v_add_u32_dpp v39, v39, v39 row_bcast:31 row_mask:0xc bank_mask:0xf
v_sub_u32 v56, v39, v38
v_add_u32 v56, 98, v56
v_add_u32 v57, v56, v60
v_readlane_b32 s35, v39, 63
ds_write_b64 v28, v[56:57] offset:30752
s_cmp_le_u32 s35, 1792
s_cbranch_scc1 K2_PAD2
s_movk_i32 s34, 1400
s_waitcnt lgkmcnt(0)
s_barrier
s_branch K2_ROUND
K2_PAD2:
ds_read_b32 v40, v160 offset:30752
ds_read_b32 v41, v161 offset:30752
ds_read_b32 v42, v162 offset:30752
ds_read_b32 v43, v163 offset:30752
ds_read_b32 v44, v164 offset:30752
ds_read_b32 v45, v165 offset:30752
ds_read_b32 v46, v166 offset:30752
v_mov_b32 v152, 0
v_mov_b32 v153, 0
v_mov_b32 v155, 0
v_add_u32 v36, s30, v36
v_cmp_lt_u32 vcc, v36, v60
v_lshl_or_b32 v58, v4, 1, 0
v_lshlrev_b32 v154, 19, v58
v_add_lshl_u32 v59, v36, v56, 4
v_or_b32 v154, 0x8000, v154
s_mov_b64 exec, vcc
ds_write_b128 v59, v[152:155]
s_mov_b64 exec, -1
v_add_u32 v36, s30, v37
v_cmp_lt_u32 vcc, v36, v61
v_lshl_or_b32 v58, v4, 1, 1
v_lshlrev_b32 v154, 19, v58
v_add_lshl_u32 v59, v36, v57, 4
v_or_b32 v154, 0x8000, v154
s_mov_b64 exec, vcc
ds_write_b128 v59, v[152:155]
s_mov_b64 exec, -1
v_mov_b32 v37, v61
v_cmp_lt_u32 s[82:83], 0, v38
s_waitcnt lgkmcnt(0)
s_branch K2_PADRET
K2_SB:
s_barrier
s_branch K2_SD
K2_K0:
v_mov_b32 v9, s45
ds_write_b32 v223, v9
v_and_b32 v248, 63, v254
v_lshrrev_b32 v249, 4, v248
s_and_b32 s57, s30, 1
v_and_b32 v250, 1, v249
s_lshl_b32 s57, s57, 3
v_lshl_or_b32 v250, v250, 2, s57
v_and_b32 v248, 15, v248
v_xor_b32 v248, v248, v250
v_lshlrev_b32 v248, 4, v248
s_lshl_b32 s56, s30, 13
s_mov_b32 m0, s46
s_add_u32 s56, s56, 32768
s_mov_b32 s26, 65536
v_lshl_or_b32 v248, v249, 8, v248
buffer_load_dwordx4 v248, s[24:27], s56 offen offset:0 lds
buffer_load_dwordx4 v248, s[24:27], s56 offen offset:1024 lds
buffer_load_dwordx4 v248, s[24:27], s56 offen offset:2048 lds
buffer_load_dwordx4 v248, s[24:27], s56 offen offset:3072 lds
s_mov_b32 m0, s47
s_add_u32 s56, s56, 4096
buffer_load_dwordx4 v248, s[24:27], s56 offen offset:0 lds
buffer_load_dwordx4 v248, s[24:27], s56 offen offset:1024 lds
buffer_load_dwordx4 v248, s[24:27], s56 offen offset:2048 lds
buffer_load_dwordx4 v248, s[24:27], s56 offen offset:3072 lds
s_branch K2_REND
s_endpgm

.section .rodata,"a"
.p2align 6
.amdhsa_kernel gather_scatter__cheap_equivariant_egnn__graph_kernel
  .amdhsa_next_free_vgpr 512
  .amdhsa_next_free_sgpr 102
  .amdhsa_accum_offset 256
  .amdhsa_group_segment_fixed_size 0
  .amdhsa_kernarg_size 88
  .amdhsa_user_sgpr_count 2
  .amdhsa_user_sgpr_kernarg_segment_ptr 1
  .amdhsa_system_sgpr_workgroup_id_x 1
.end_amdhsa_kernel
```
